```python
import torch

def _softmax(x, axis=-1):
    return torch.softmax(x, dim=axis)
def _gelu(x):
    return torch.nn.functional.gelu(x, approximate="tanh")
def _silu(x):
    return torch.nn.functional.silu(x)
def _sigmoid(x):
    return torch.sigmoid(x)
def _layernorm(x, axis=-1, eps=1e-5):
    m = x.mean(dim=axis, keepdim=True)
    v = x.var(dim=axis, keepdim=True, unbiased=False)
    return (x - m) / torch.sqrt(v + eps)
def _scatter_add(tgt, idx, src, axis=0):
    return tgt.clone().index_add_(axis, idx, src)
def _segment_sum(src, seg, n):
    out = torch.zeros((n,) + src.shape[1:], dtype=src.dtype)
    return out.index_add_(0, seg, src)
def _pad(x, pw):
    flat = tuple(v for pair in reversed(pw) for v in pair)
    return torch.nn.functional.pad(x, flat)

kernel_name = 'recurrent_scan__ssm_conv_s4__mixer_channel_mlp__prompt'

def setup_inputs():

    _w = (lambda a: (lambda t: t.to(torch.bfloat16) if t.is_floating_point() else t)(torch.as_tensor(a)))
    def _A_setup():
        B, L, D, N = 1, 2048, 640, 128
        A_re = -(lambda _x: torch.exp(torch.as_tensor(_x)))((lambda *s: torch.randn(*s, dtype=torch.bfloat16) * 3.2)(D, N))
        A_im = torch.pi * (lambda *s: torch.randn(*s, dtype=torch.bfloat16) * 0.05)(D, N)
        B_re = (lambda *s: torch.randn(*s, dtype=torch.bfloat16) * 0.2)(D, N)
        B_im = (lambda *s: torch.randn(*s, dtype=torch.bfloat16) * 0.2)(D, N)
        C_re = (lambda *s: torch.randn(*s, dtype=torch.bfloat16) * 0.2)(D, N)
        C_im = (lambda *s: torch.randn(*s, dtype=torch.bfloat16) * 0.2)(D, N)
        log_dt = (lambda *s: torch.randn(*s, dtype=torch.bfloat16) * 0.05)(D) * 0.5 - 4.0
        Dskip = (lambda *s: torch.randn(*s, dtype=torch.bfloat16) * 0.05)(D)
        return {
            "u": _w((lambda *s: torch.randn(*s, dtype=torch.bfloat16) * 0.05)(B, L, D)),
            "A_re": _w(A_re),
            "A_im": _w(A_im),
            "B_re": _w(B_re),
            "B_im": _w(B_im),
            "C_re": _w(C_re),
            "C_im": _w(C_im),
            "log_dt": _w(log_dt),
            "Dskip": _w(Dskip),
        }
    _A_in = _A_setup()

    def _B_setup():
        B, S, D, F = 1, 2048, 640, 1728
        return {
            "x": _w((lambda *s: torch.randn(*s, dtype=torch.bfloat16) * 0.05)(B, S, D)),
            "w1": _w((lambda *s: torch.randn(*s, dtype=torch.bfloat16) * 3.2)(D, F) * (D ** -0.5)),
            "b1": _w((lambda *s: torch.randn(*s, dtype=torch.bfloat16) * 0.8)(F)),
            "w2": _w((lambda *s: torch.randn(*s, dtype=torch.bfloat16) * 0.05)(F, D) * (F ** -0.5)),
            "b2": _w((lambda *s: torch.randn(*s, dtype=torch.bfloat16) * 0.05)(D)),
        }
    _B_in = _B_setup()

    return {
        "A_u": _A_in["u"],
        "A_A_re": _A_in["A_re"],
        "A_A_im": _A_in["A_im"],
        "A_B_re": _A_in["B_re"],
        "A_B_im": _A_in["B_im"],
        "A_C_re": _A_in["C_re"],
        "A_C_im": _A_in["C_im"],
        "A_log_dt": _A_in["log_dt"],
        "A_Dskip": _A_in["Dskip"],
        "B_x": _B_in["x"],
        "B_w1": _B_in["w1"],
        "B_b1": _B_in["b1"],
        "B_w2": _B_in["w2"],
        "B_b2": _B_in["b2"],
    }

def reference(A_u, A_A_re, A_A_im, A_B_re, A_B_im, A_C_re, A_C_im, A_log_dt, A_Dskip, B_x, B_w1, B_b1, B_w2, B_b2):
    def _A_ref(u, A_re, A_im, B_re, B_im, C_re, C_im, log_dt, Dskip):
        Bsz, L, D = u.shape
        dt = torch.exp(log_dt)[:, None]
        A = A_re + 1j * A_im
        Bc = B_re + 1j * B_im
        Cc = C_re + 1j * C_im
        logdA = dt * A
        dB = dt * Bc
        l = (lambda x, dt: x.to(dt))(torch.arange(L), A_re.dtype)
        P = torch.exp(logdA[:, :, None] * l[None, None, :])
        K = torch.einsum("dn,dnl,dn->dl", Cc, P, dB).real
        L2 = 2 * L
        Kp = _pad(K, ((0, 0), (0, L)))
        up = (lambda x, *d: x.permute(*d))(u, 0, 2, 1)
        up = _pad(up, ((0, 0), (0, 0), (0, L)))
        Kf = (lambda x, axes=(-2,-1): torch.fft.rfft2(x.float(), dim=axes))(Kp[:, None, :], axes=(-2, -1))
        Uf = (lambda x, axes=(-2,-1): torch.fft.rfft2(x.float(), dim=axes))(up[:, :, None, :], axes=(-2, -1))
        Yf = Uf * Kf[None, :, :, :]
        y = (lambda x, s, axes=(-2,-1): torch.fft.irfft2(x, s=s, dim=axes).to(torch.bfloat16))(Yf, (1, L2), axes=(-2, -1))[:, :, 0, :L]
        y = (lambda x, *d: x.permute(*d))(y, 0, 2, 1) + u * Dskip[None, None, :]
        return y

    def _B_ref(x, w1, b1, w2, b2):
        y = _layernorm(x, axis=-1)
        h = _gelu(torch.einsum("bsd,df->bsf", y, w1) + b1)
        return torch.einsum("bsf,fd->bsd", h, w2) + b2

    x = A_u
    xn = _layernorm(x, axis=-1)
    s = _A_ref(xn, A_A_re, A_A_im, A_B_re, A_B_im, A_C_re, A_C_im, A_log_dt, A_Dskip)
    g = _silu(_B_ref(xn, B_w1, B_b1, B_w2, B_b2))
    return x + s * g
```

```asm
; @launch grid=(504,1,1) block=(256,1,1) lds=81920
.amdgcn_target "amdgcn-amd-amdhsa--gfx950"
.text
.globl recurrent_scan__ssm_conv_s4__mixer_channel_mlp__prompt_kernel
.p2align 8
.type recurrent_scan__ssm_conv_s4__mixer_channel_mlp__prompt_kernel,@function
recurrent_scan__ssm_conv_s4__mixer_channel_mlp__prompt_kernel:
  s_mov_b32 s3, 16128
L_main:
  s_cmp_ge_u32 s2, 504
  s_cbranch_scc1 L_exit
  s_load_dwordx2 s[4:5], s[0:1], 128
  s_load_dwordx4 s[52:55], s[0:1], 96
  v_lshrrev_b32 v1, 6, v0
  v_and_b32 v2, 63, v0
  v_readfirstlane_b32 s12, v1
  s_lshr_b32 s24, s2, 3
  s_sub_u32 s19, s24, 8
  s_cmp_lt_u32 s19, 23
  s_cbranch_scc1 R_S
  s_sub_u32 s19, s24, 13
  s_sub_u32 s20, s24, 36
  s_cmp_lt_u32 s20, 4
  s_cbranch_scc1 R_S
  s_load_dwordx2 s[16:17], s[0:1], 0
  s_load_dwordx4 s[96:99], s[0:1], 80
  s_load_dwordx2 s[100:101], s[0:1], 112
  s_bfe_u32 s22, s2, 0x20001
  s_and_b32 s23, s2, 1
  s_lshl_b32 s20, s22, 2
  s_cmp_lt_u32 s24, 4
  s_cbranch_scc1 L_aux
  s_sub_u32 s24, s24, 4
  s_cmp_lt_u32 s24, 4
  s_cbranch_scc1 L_gln
  s_cmp_lt_u32 s24, 32
  s_cselect_b32 s25, 27, 31
  s_sub_u32 s25, s24, s25
  s_mul_i32 s26, s25, 37
  s_lshr_b32 s26, s26, 8
  s_mul_i32 s27, s26, 7
  s_sub_u32 s27, s25, s27
  s_add_u32 s20, s20, s26
  s_mul_i32 s21, s23, 7
  s_add_u32 s21, s21, s27
  s_mov_b32 s14, s20
  s_cmp_ge_u32 s27, s26
  s_addc_u32 s28, s27, 0
  s_and_b32 s13, s28, 3
  s_lshl_b32 s28, s28, 1
  s_and_b32 s28, s28, 8
  s_lshl2_add_u32 s13, s23, s13
  s_add_u32 s13, s13, s28
  s_add_u32 s18, s26, s27
  s_add_u32 s18, s18, s22
  s_and_b32 s18, s18, 3
  s_mul_i32 s18, s18, 5
  s_setprio 1
  s_branch R_G1
L_gln:
  s_setprio 3
  s_add_u32 s20, s20, s24
  s_mov_b32 s21, s23
  s_lshl2_add_u32 s13, s23, s24
  s_mov_b32 s14, s20
  s_lshl3_add_u32 s18, s22, s24
  s_branch R_LN
L_aux:
  s_setprio 3
  s_add_u32 s20, s20, s24
  s_add_u32 s21, s23, 2
  s_lshl3_add_u32 s18, s22, s24
  s_add_u32 s18, s18, 4
  s_branch R_LN
L_exit:
  s_endpgm
R_G1:
  s_lshr_b32 s22, s12, 1
  s_and_b32 s23, s12, 1
  v_lshrrev_b32 v3, 2, v2
  v_and_b32 v4, 3, v2
  v_lshrrev_b32 v5, 4, v2
  v_xor_b32 v4, v4, v5
  s_lshl_b32 s24, s20, 7
  s_lshl_b32 s25, s12, 5
  s_add_u32 s24, s24, s25
  v_add_u32 v6, s24, v3
  v_mul_u32_u24 v6, 1280, v6
  v_lshl_add_u32 v8, v4, 4, v6
  v_add_u32 v9, 19456, v8
  v_and_b32 v4, 15, v2
  v_lshlrev_b32 v6, 2, v5
  v_xor_b32 v4, v4, v6
  s_lshl_b32 s25, s12, 3
  v_add_u32 v6, s25, v5
  v_mul_u32_u24 v6, 3456, v6
  v_lshl_add_u32 v10, v4, 4, v6
  s_lshl_b32 s25, s21, 8
  v_add_u32 v10, s25, v10
  v_add_u32 v11, 12800, v10
  s_lshl_b32 s32, s12, 12
  s_lshl_b32 s56, s18, 6
  s_mul_i32 s57, s18, 110592
  s_waitcnt lgkmcnt(0)
  s_mov_b32 s24, s16
  s_mov_b32 s25, s17
  s_mov_b32 s26, 2621440
  s_mov_b32 s27, 0x00020000
  s_sub_u32 s28, s96, 2048
  s_subb_u32 s29, s97, 0
  s_mov_b32 s30, 2213888
  s_mov_b32 s31, 0x00020000
  s_add_u32 m0, s32, 0
  s_nop 0
  buffer_load_dwordx4 v8, s[24:27], s56 offen offset:0 lds
  buffer_load_dwordx4 v10, s[28:31], s57 offen offset:2048 lds
  buffer_load_dwordx4 v9, s[24:27], s56 offen offset:1024 lds
  s_add_u32 s56, s56, 64
  buffer_load_dwordx4 v11, s[28:31], s57 offen offset:3072 lds
  s_add_u32 s57, s57, 110592
  s_add_u32 m0, s32, 16384
  s_nop 0
  buffer_load_dwordx4 v8, s[24:27], s56 offen offset:0 lds
  buffer_load_dwordx4 v10, s[28:31], s57 offen offset:2048 lds
  buffer_load_dwordx4 v9, s[24:27], s56 offen offset:1024 lds
  s_add_u32 s56, s56, 64
  buffer_load_dwordx4 v11, s[28:31], s57 offen offset:3072 lds
  s_add_u32 s57, s57, 110592
  s_add_u32 m0, s32, 32768
  s_nop 0
  buffer_load_dwordx4 v8, s[24:27], s56 offen offset:0 lds
  buffer_load_dwordx4 v10, s[28:31], s57 offen offset:2048 lds
  buffer_load_dwordx4 v9, s[24:27], s56 offen offset:1024 lds
  s_add_u32 s56, s56, 64
  buffer_load_dwordx4 v11, s[28:31], s57 offen offset:3072 lds
  s_add_u32 s57, s57, 110592
  s_add_u32 m0, s32, 49152
  s_nop 0
  buffer_load_dwordx4 v8, s[24:27], s56 offen offset:0 lds
  buffer_load_dwordx4 v10, s[28:31], s57 offen offset:2048 lds
  buffer_load_dwordx4 v9, s[24:27], s56 offen offset:1024 lds
  s_add_u32 s56, s56, 64
  buffer_load_dwordx4 v11, s[28:31], s57 offen offset:3072 lds
  s_add_u32 s57, s57, 110592
  s_setprio 3
  s_mov_b32 s40, s98
  s_mov_b32 s41, s99
  s_mov_b32 s42, 3456
  s_mov_b32 s43, 0x00020000
  v_and_b32 v3, 31, v2
  s_lshl_b32 s34, s21, 7
  s_lshl_b32 s35, s12, 5
  s_add_u32 s34, s34, s35
  v_add_u32 v4, s34, v3
  v_lshlrev_b32 v22, 3, v4
  v_lshlrev_b32 v4, 1, v4
  v_xor_b32 v6, 64, v4
  buffer_load_ushort v14, v4, s[40:43], 0 offen
  buffer_load_ushort v15, v6, s[40:43], 0 offen
  s_add_u32 s8, s4, 20971520
  s_addc_u32 s9, s5, 0
  s_mov_b32 s10, 262144
  s_mov_b32 s11, 0x00020000
  s_buffer_load_dword s15, s[8:11], 49152
  s_mov_b32 s44, s4
  s_mov_b32 s45, s5
  s_mov_b32 s46, 7077888
  s_mov_b32 s47, 0x00020000
  v_lshrrev_b32 v4, 5, v2
  v_bfe_u32 v6, v3, 2, 2
  v_xor_b32 v6, v6, v4
  s_lshl_b32 s34, s23, 6
  v_add_u32 v7, s34, v3
  s_lshl_b32 s35, s20, 7
  v_add_u32 v23, s35, v7
  v_lshlrev_b32 v23, 4, v23
  v_lshlrev_b32 v7, 6, v3
  s_lshl_b32 s34, s23, 13
  v_add_u32 v7, s34, v7
  v_lshl_add_u32 v16, v6, 4, v7
  v_xor_b32 v6, 2, v6
  v_lshl_add_u32 v17, v6, 4, v7
  v_bfe_u32 v6, v2, 2, 2
  v_and_b32 v7, 3, v2
  v_lshl_add_u32 v12, v4, 4, v6
  v_lshlrev_b32 v12, 8, v12
  v_and_b32 v13, 1, v5
  v_lshl_add_u32 v12, v13, 5, v12
  v_lshl_add_u32 v12, v7, 3, v12
  v_add_u32 v12, 2048, v12
  v_xor_b32 v13, s12, v6
  v_lshl_add_u32 v20, v13, 6, v12
  v_xor_b32 v13, 1, v13
  v_lshl_add_u32 v21, v13, 6, v12
  v_add_u32 v58, 65536, v16
  v_add_u32 v59, 65536, v17
  v_add_u32 v60, 65536, v20
  v_add_u32 v61, 65536, v21
  v_xor_b32 v62, 256, v22
  v_min_u32 v22, 13816, v22
  v_add_u32 v22, 32768, v22
  v_min_u32 v62, 13816, v62
  v_add_u32 v62, 32768, v62
  v_mov_b32 v64, 0
  v_mov_b32 v65, 0
  v_mov_b32 v66, 0
  v_mov_b32 v67, 0
  v_mov_b32 v68, 0
  v_mov_b32 v69, 0
  v_mov_b32 v70, 0
  v_mov_b32 v71, 0
  v_mov_b32 v72, 0
  v_mov_b32 v73, 0
  v_mov_b32 v74, 0
  v_mov_b32 v75, 0
  v_mov_b32 v76, 0
  v_mov_b32 v77, 0
  v_mov_b32 v78, 0
  v_mov_b32 v79, 0
  v_mov_b32 v80, 0
  v_mov_b32 v81, 0
  v_mov_b32 v82, 0
  v_mov_b32 v83, 0
  v_mov_b32 v84, 0
  v_mov_b32 v85, 0
  v_mov_b32 v86, 0
  v_mov_b32 v87, 0
  v_mov_b32 v88, 0
  v_mov_b32 v89, 0
  v_mov_b32 v90, 0
  v_mov_b32 v91, 0
  v_mov_b32 v92, 0
  v_mov_b32 v93, 0
  v_mov_b32 v94, 0
  v_mov_b32 v95, 0
  v_mov_b32 v96, 0
  v_mov_b32 v97, 0
  v_mov_b32 v98, 0
  v_mov_b32 v99, 0
  v_mov_b32 v100, 0
  v_mov_b32 v101, 0
  v_mov_b32 v102, 0
  v_mov_b32 v103, 0
  v_mov_b32 v104, 0
  v_mov_b32 v105, 0
  v_mov_b32 v106, 0
  v_mov_b32 v107, 0
  v_mov_b32 v108, 0
  v_mov_b32 v109, 0
  v_mov_b32 v110, 0
  v_mov_b32 v111, 0
  v_mov_b32 v112, 0
  v_mov_b32 v113, 0
  v_mov_b32 v114, 0
  v_mov_b32 v115, 0
  v_mov_b32 v116, 0
  v_mov_b32 v117, 0
  v_mov_b32 v118, 0
  v_mov_b32 v119, 0
  v_mov_b32 v120, 0
  v_mov_b32 v121, 0
  v_mov_b32 v122, 0
  v_mov_b32 v123, 0
  v_mov_b32 v124, 0
  v_mov_b32 v125, 0
  v_mov_b32 v126, 0
  v_mov_b32 v127, 0
  s_mov_b32 s65, 0
  v_min_u32 v13, 53, v2
  v_lshlrev_b32 v13, 4, v13
  s_and_b32 s61, s2, 7
  s_bfe_u32 s88, s13, 0x20001
  s_lshl2_add_u32 s61, s61, s88
  s_lshl_b32 s61, s61, 10
  s_add_u32 s61, s61, 196608
  v_lshrrev_b32 v4, 5, v2
  v_lshlrev_b32 v4, 4, v4
  v_mov_b32 v130, 0
  v_mov_b32 v131, 0
  v_mov_b32 v134, 0
  v_mov_b32 v135, 0
  v_mov_b32 v136, 0
  v_mov_b32 v137, 0
  v_mov_b32 v138, 0
  v_mov_b32 v139, 0
  v_mov_b32 v140, 0
  v_mov_b32 v141, 0
  v_mov_b32 v142, 0
  v_mov_b32 v143, 0
  v_lshrrev_b32 v7, 4, v3
  v_lshlrev_b32 v7, 10, v7
  v_lshl_add_u32 v7, v4, 4, v7
  v_and_b32 v12, 15, v2
  v_lshl_add_u32 v12, v12, 4, v7
  s_lshl_b32 s34, s20, 1
  s_add_u32 s34, s34, s23
  s_mul_i32 s34, s34, 54
  s_lshl_b32 s35, s21, 2
  s_add_u32 s34, s34, s35
  s_add_u32 s34, s34, s12
  s_xor_b32 s35, s34, 1
  s_lshl_b32 s62, s34, 12
  s_lshl_b32 s63, s35, 12
  s_cmp_eq_u32 s21, 13
  s_cselect_b32 s64, s22, 0
  s_mov_b32 s71, s21
  s_lshl_b32 s67, s21, 2
  s_lshl_b32 s69, s20, 12
  s_add_u32 s69, s69, 131072
  s_mul_i32 s70, s20, 56
  s_add_u32 s70, s70, 50176
  v_lshl_add_u32 v63, v2, 8, s69
  v_writelane_b32 v63, s70, 16
  s_and_b32 s21, s13, 7
  s_lshl2_add_u32 s18, s71, s12
  s_mul_i32 s23, s21, 276480
  s_add_u32 s23, s23, 8388608
  s_add_u32 s36, s4, s23
  s_addc_u32 s37, s5, 0
  s_mov_b32 s38, 276480
  s_mov_b32 s39, 0x00020000
  v_lshlrev_b32 v4, 4, v2
  v_add_u32 v5, 4096, v4
  s_mul_i32 s33, s18, 5120
  s_mov_b32 s34, s33
  s_waitcnt vmcnt(14) lgkmcnt(0)
  s_add_u32 s15, s15, 1
  s_barrier
  ds_read_b64_tr_b16 v[24:25], v20 offset:0
  ds_read_b64_tr_b16 v[26:27], v20 offset:1024
  ds_read_b128 v[32:35], v16 offset:0
  ds_read_b128 v[36:39], v16 offset:4096
  ds_read_b64_tr_b16 v[28:29], v21 offset:0
  ds_read_b64_tr_b16 v[30:31], v21 offset:1024
  ds_read_b64_tr_b16 v[40:41], v20 offset:8192
  ds_read_b64_tr_b16 v[42:43], v20 offset:9216
  ds_read_b128 v[48:51], v17 offset:0
  ds_read_b128 v[52:55], v17 offset:4096
.p2align 6
L_g1loop:
  s_waitcnt vmcnt(8) lgkmcnt(4)
  s_barrier
  v_mfma_f32_32x32x16_bf16 v[64:79], v[24:27], v[32:35], v[64:79]
  ds_read_b64_tr_b16 v[44:45], v21 offset:8192
  ds_read_b64_tr_b16 v[46:47], v21 offset:9216
  v_mfma_f32_32x32x16_bf16 v[80:95], v[24:27], v[36:39], v[80:95]
  ds_read_b64_tr_b16 v[24:25], v20 offset:16384
  ds_read_b64_tr_b16 v[26:27], v20 offset:17408
  v_mfma_f32_32x32x16_bf16 v[96:111], v[28:31], v[32:35], v[96:111]
  ds_read_b128 v[32:35], v16 offset:16384
  s_add_u32 m0, s32, 65536
  s_nop 0
  buffer_load_dwordx4 v8, s[24:27], s56 offen offset:0 lds
  v_mfma_f32_32x32x16_bf16 v[112:127], v[28:31], v[36:39], v[112:127]
  ds_read_b128 v[36:39], v16 offset:20480
  buffer_load_dwordx4 v10, s[28:31], s57 offen offset:2048 lds
  s_waitcnt lgkmcnt(4)
  v_mfma_f32_32x32x16_bf16 v[64:79], v[40:43], v[48:51], v[64:79]
  ds_read_b64_tr_b16 v[28:29], v21 offset:16384
  ds_read_b64_tr_b16 v[30:31], v21 offset:17408
  v_mfma_f32_32x32x16_bf16 v[80:95], v[40:43], v[52:55], v[80:95]
  ds_read_b64_tr_b16 v[40:41], v20 offset:24576
  ds_read_b64_tr_b16 v[42:43], v20 offset:25600
  v_mfma_f32_32x32x16_bf16 v[96:111], v[44:47], v[48:51], v[96:111]
  ds_read_b128 v[48:51], v17 offset:16384
  buffer_load_dwordx4 v9, s[24:27], s56 offen offset:1024 lds
  s_add_u32 s56, s56, 64
  v_mfma_f32_32x32x16_bf16 v[112:127], v[44:47], v[52:55], v[112:127]
  ds_read_b128 v[52:55], v17 offset:20480
  buffer_load_dwordx4 v11, s[28:31], s57 offen offset:3072 lds
  s_add_u32 s57, s57, 110592
  s_waitcnt vmcnt(8) lgkmcnt(4)
  s_barrier
  v_mfma_f32_32x32x16_bf16 v[64:79], v[24:27], v[32:35], v[64:79]
  ds_read_b64_tr_b16 v[44:45], v21 offset:24576
  ds_read_b64_tr_b16 v[46:47], v21 offset:25600
  s_cmp_lg_u32 s65, 3
  s_cbranch_scc1 L_g1x1
  s_waitcnt vmcnt(8)
  s_bitcmp1_b32 s3, 12
  s_cbranch_scc0 Lpd_2
  s_mov_b32 s91, 0
Lpl_1:
  v_cmp_ne_u32 vcc, s15, v168
  v_cmp_ne_u32 s[88:89], s15, v169
  s_nop 0
  s_or_b64 vcc, vcc, s[88:89]
  v_cmp_ne_u32 s[88:89], s15, v170
  s_nop 0
  s_or_b64 vcc, vcc, s[88:89]
  v_cmp_ne_u32 s[88:89], s15, v171
  s_nop 0
  s_or_b64 vcc, vcc, s[88:89]
  s_add_u32 s91, s91, 1
  s_cmp_eq_u64 vcc, 0
  s_cbranch_scc1 Lpd_2
  s_sleep 8
  buffer_load_dwordx4 v[168:171], v13, s[8:11], s61 offen sc1
  s_waitcnt vmcnt(0)
  s_cmp_lt_u32 s91, 32768
  s_cbranch_scc1 Lpl_1
Lpd_2:
  s_mov_b64 s[24:25], s[36:37]
  s_mov_b32 s26, s38
  s_mov_b64 s[28:29], s[36:37]
  s_mov_b32 s30, s38
  v_mov_b32 v8, v4
  v_mov_b32 v9, v4
  v_mov_b32 v10, v4
  v_mov_b32 v11, v4
  s_add_u32 s34, s34, 20480
  s_cmp_ge_u32 s34, 286720
  s_cselect_b32 s19, 286720, 0
  s_sub_u32 s34, s34, s19
  s_min_u32 s56, s34, 271360
  s_mov_b32 s57, s56
  s_mov_b32 s40, s56
L_g1x1:
  v_mfma_f32_32x32x16_bf16 v[80:95], v[24:27], v[36:39], v[80:95]
  ds_read_b64_tr_b16 v[24:25], v20 offset:32768
  ds_read_b64_tr_b16 v[26:27], v20 offset:33792
  s_cmp_eq_u32 s56, 1280
  s_cmov_b64 s[56:57], 0
  v_mfma_f32_32x32x16_bf16 v[96:111], v[28:31], v[32:35], v[96:111]
  ds_read_b128 v[32:35], v16 offset:32768
  s_add_u32 m0, s32, 0
  s_nop 0
  buffer_load_dwordx4 v8, s[24:27], s56 offen offset:0 lds
  v_mfma_f32_32x32x16_bf16 v[112:127], v[28:31], v[36:39], v[112:127]
  ds_read_b128 v[36:39], v16 offset:36864
  buffer_load_dwordx4 v10, s[28:31], s57 offen offset:2048 lds
  s_waitcnt lgkmcnt(4)
  v_mfma_f32_32x32x16_bf16 v[64:79], v[40:43], v[48:51], v[64:79]
  ds_read_b64_tr_b16 v[28:29], v21 offset:32768
  ds_read_b64_tr_b16 v[30:31], v21 offset:33792
  v_mfma_f32_32x32x16_bf16 v[80:95], v[40:43], v[52:55], v[80:95]
  ds_read_b64_tr_b16 v[40:41], v20 offset:40960
  ds_read_b64_tr_b16 v[42:43], v20 offset:41984
  v_mfma_f32_32x32x16_bf16 v[96:111], v[44:47], v[48:51], v[96:111]
  ds_read_b128 v[48:51], v17 offset:32768
  buffer_load_dwordx4 v9, s[24:27], s56 offen offset:1024 lds
  s_add_u32 s56, s56, 64
  v_mfma_f32_32x32x16_bf16 v[112:127], v[44:47], v[52:55], v[112:127]
  ds_read_b128 v[52:55], v17 offset:36864
  buffer_load_dwordx4 v11, s[28:31], s57 offen offset:3072 lds
  s_add_u32 s57, s57, 110592
  s_waitcnt vmcnt(8) lgkmcnt(4)
  s_barrier
  v_mfma_f32_32x32x16_bf16 v[64:79], v[24:27], v[32:35], v[64:79]
  ds_read_b64_tr_b16 v[44:45], v21 offset:40960
  ds_read_b64_tr_b16 v[46:47], v21 offset:41984
  s_cmp_lg_u32 s65, 3
  s_cbranch_scc1 L_g1x2
  s_add_u32 s34, s34, 40960
  s_cmp_ge_u32 s34, 286720
  s_cselect_b32 s19, 286720, 0
  s_sub_u32 s34, s34, s19
  s_min_u32 s56, s34, 271360
  s_mov_b32 s57, s56
  s_mov_b32 s41, s56
L_g1x2:
  v_mfma_f32_32x32x16_bf16 v[80:95], v[24:27], v[36:39], v[80:95]
  ds_read_b64_tr_b16 v[24:25], v20 offset:49152
  ds_read_b64_tr_b16 v[26:27], v20 offset:50176
  v_mfma_f32_32x32x16_bf16 v[96:111], v[28:31], v[32:35], v[96:111]
  ds_read_b128 v[32:35], v16 offset:49152
  s_add_u32 m0, s32, 16384
  s_nop 0
  buffer_load_dwordx4 v8, s[24:27], s56 offen offset:0 lds
  v_mfma_f32_32x32x16_bf16 v[112:127], v[28:31], v[36:39], v[112:127]
  ds_read_b128 v[36:39], v16 offset:53248
  buffer_load_dwordx4 v10, s[28:31], s57 offen offset:2048 lds
  s_waitcnt lgkmcnt(4)
  v_mfma_f32_32x32x16_bf16 v[64:79], v[40:43], v[48:51], v[64:79]
  ds_read_b64_tr_b16 v[28:29], v21 offset:49152
  ds_read_b64_tr_b16 v[30:31], v21 offset:50176
  v_mfma_f32_32x32x16_bf16 v[80:95], v[40:43], v[52:55], v[80:95]
  ds_read_b64_tr_b16 v[40:41], v20 offset:57344
  ds_read_b64_tr_b16 v[42:43], v20 offset:58368
  v_mfma_f32_32x32x16_bf16 v[96:111], v[44:47], v[48:51], v[96:111]
  ds_read_b128 v[48:51], v17 offset:49152
  buffer_load_dwordx4 v9, s[24:27], s56 offen offset:1024 lds
  s_add_u32 s56, s56, 64
  v_mfma_f32_32x32x16_bf16 v[112:127], v[44:47], v[52:55], v[112:127]
  ds_read_b128 v[52:55], v17 offset:53248
  buffer_load_dwordx4 v11, s[28:31], s57 offen offset:3072 lds
  s_add_u32 s57, s57, 110592
  s_waitcnt vmcnt(8) lgkmcnt(4)
  s_barrier
  v_mfma_f32_32x32x16_bf16 v[64:79], v[24:27], v[32:35], v[64:79]
  ds_read_b64_tr_b16 v[44:45], v21 offset:57344
  ds_read_b64_tr_b16 v[46:47], v21 offset:58368
  s_cmp_lg_u32 s65, 3
  s_cbranch_scc1 L_g1x3
  s_add_u32 s34, s34, 40960
  s_cmp_ge_u32 s34, 286720
  s_cselect_b32 s19, 286720, 0
  s_sub_u32 s34, s34, s19
  s_min_u32 s56, s34, 271360
  s_mov_b32 s57, s56
  s_mov_b32 s42, s56
  buffer_load_dwordx2 v[18:19], v22, s[8:11], 0 offen
  buffer_load_dwordx2 v[56:57], v62, s[8:11], 0 offen
  buffer_load_dwordx4 v[160:163], v23, s[8:11], 0 offen
  buffer_load_dwordx4 v[164:167], v23, s[8:11], 0 offen offset:512
L_g1x3:
  v_mfma_f32_32x32x16_bf16 v[80:95], v[24:27], v[36:39], v[80:95]
  ds_read_b64_tr_b16 v[24:25], v60 offset:0
  ds_read_b64_tr_b16 v[26:27], v60 offset:1024
  v_mfma_f32_32x32x16_bf16 v[96:111], v[28:31], v[32:35], v[96:111]
  ds_read_b128 v[32:35], v58 offset:0
  s_add_u32 m0, s32, 32768
  s_nop 0
  buffer_load_dwordx4 v8, s[24:27], s56 offen offset:0 lds
  v_mfma_f32_32x32x16_bf16 v[112:127], v[28:31], v[36:39], v[112:127]
  ds_read_b128 v[36:39], v58 offset:4096
  buffer_load_dwordx4 v10, s[28:31], s57 offen offset:2048 lds
  s_waitcnt lgkmcnt(4)
  v_mfma_f32_32x32x16_bf16 v[64:79], v[40:43], v[48:51], v[64:79]
  ds_read_b64_tr_b16 v[28:29], v61 offset:0
  ds_read_b64_tr_b16 v[30:31], v61 offset:1024
  v_mfma_f32_32x32x16_bf16 v[80:95], v[40:43], v[52:55], v[80:95]
  ds_read_b64_tr_b16 v[40:41], v60 offset:8192
  ds_read_b64_tr_b16 v[42:43], v60 offset:9216
  v_mfma_f32_32x32x16_bf16 v[96:111], v[44:47], v[48:51], v[96:111]
  ds_read_b128 v[48:51], v59 offset:0
  buffer_load_dwordx4 v9, s[24:27], s56 offen offset:1024 lds
  s_add_u32 s56, s56, 64
  v_mfma_f32_32x32x16_bf16 v[112:127], v[44:47], v[52:55], v[112:127]
  ds_read_b128 v[52:55], v59 offset:4096
  buffer_load_dwordx4 v11, s[28:31], s57 offen offset:3072 lds
  s_add_u32 s57, s57, 110592
  s_cmp_eq_u32 s65, 3
  s_cbranch_scc1 L_g1w4
  s_waitcnt vmcnt(8)
L_g1w4:
  s_waitcnt lgkmcnt(4)
  s_barrier
  v_mfma_f32_32x32x16_bf16 v[64:79], v[24:27], v[32:35], v[64:79]
  ds_read_b64_tr_b16 v[44:45], v61 offset:8192
  ds_read_b64_tr_b16 v[46:47], v61 offset:9216
  s_cmp_lg_u32 s65, 2
  s_cbranch_scc1 L_g1y
  buffer_load_dwordx4 v[168:171], v13, s[8:11], s61 offen
L_g1y:
  s_cmp_lg_u32 s65, 3
  s_cbranch_scc1 L_g1x4
  s_add_u32 s34, s34, 40960
  s_cmp_ge_u32 s34, 286720
  s_cselect_b32 s19, 286720, 0
  s_sub_u32 s34, s34, s19
  s_min_u32 s56, s34, 271360
  s_mov_b32 s57, s56
  s_mov_b32 s43, s56
L_g1x4:
  v_mfma_f32_32x32x16_bf16 v[80:95], v[24:27], v[36:39], v[80:95]
  ds_read_b64_tr_b16 v[24:25], v20 offset:0
  ds_read_b64_tr_b16 v[26:27], v20 offset:1024
  v_mfma_f32_32x32x16_bf16 v[96:111], v[28:31], v[32:35], v[96:111]
  ds_read_b128 v[32:35], v16 offset:0
  s_add_u32 m0, s32, 49152
  s_nop 0
  buffer_load_dwordx4 v8, s[24:27], s56 offen offset:0 lds
  v_mfma_f32_32x32x16_bf16 v[112:127], v[28:31], v[36:39], v[112:127]
  ds_read_b128 v[36:39], v16 offset:4096
  buffer_load_dwordx4 v10, s[28:31], s57 offen offset:2048 lds
  s_waitcnt lgkmcnt(4)
  v_mfma_f32_32x32x16_bf16 v[64:79], v[40:43], v[48:51], v[64:79]
  ds_read_b64_tr_b16 v[28:29], v21 offset:0
  ds_read_b64_tr_b16 v[30:31], v21 offset:1024
  v_mfma_f32_32x32x16_bf16 v[80:95], v[40:43], v[52:55], v[80:95]
  ds_read_b64_tr_b16 v[40:41], v20 offset:8192
  ds_read_b64_tr_b16 v[42:43], v20 offset:9216
  v_mfma_f32_32x32x16_bf16 v[96:111], v[44:47], v[48:51], v[96:111]
  ds_read_b128 v[48:51], v17 offset:0
  buffer_load_dwordx4 v9, s[24:27], s56 offen offset:1024 lds
  s_add_u32 s56, s56, 64
  v_mfma_f32_32x32x16_bf16 v[112:127], v[44:47], v[52:55], v[112:127]
  ds_read_b128 v[52:55], v17 offset:4096
  buffer_load_dwordx4 v11, s[28:31], s57 offen offset:3072 lds
  s_add_u32 s57, s57, 110592
  s_add_u32 s65, s65, 1
  s_cmp_lt_u32 s65, 4
  s_cbranch_scc1 L_g1loop
  s_mov_b32 s91, 0
  s_waitcnt vmcnt(8)
L_g1rec:
  v_cmp_ne_u32 vcc, s15, v19
  v_cmp_ne_u32 s[88:89], s15, v57
  s_nop 0
  s_or_b64 vcc, vcc, s[88:89]
  v_cmp_ne_u32 s[88:89], s15, v163
  s_nop 0
  s_or_b64 vcc, vcc, s[88:89]
  v_cmp_ne_u32 s[88:89], s15, v167
  s_nop 0
  s_or_b64 vcc, vcc, s[88:89]
  s_add_u32 s91, s91, 1
  s_cmp_eq_u64 vcc, 0
  s_cbranch_scc1 L_g1recd
  s_sleep 8
  buffer_load_dwordx2 v[18:19], v22, s[8:11], 0 offen sc1
  buffer_load_dwordx2 v[56:57], v62, s[8:11], 0 offen sc1
  buffer_load_dwordx4 v[160:163], v23, s[8:11], 0 offen sc1
  buffer_load_dwordx4 v[164:167], v23, s[8:11], 0 offen offset:512 sc1
  s_waitcnt vmcnt(0)
  s_cmp_lt_u32 s91, 0x8000
  s_cbranch_scc1 L_g1rec
L_g1recd:
  v_lshlrev_b32 v6, 16, v14
  v_lshlrev_b32 v7, 16, v15
  v_mov_b64 v[128:129], v[160:161]
  v_mov_b64 v[132:133], v[164:165]
  s_mov_b32 exec_hi, 0
  v_cvt_pk_bf16_f32 v136, v18, v6
  v_mov_b32 v137, v14
  v_cvt_pk_bf16_f32 v140, v56, v7
  v_mov_b32 v141, v15
  s_mov_b32 exec_hi, -1
  v_mfma_f32_32x32x16_bf16 v[64:79], v[136:139], v[128:131], v[64:79]
  v_mfma_f32_32x32x16_bf16 v[80:95], v[136:139], v[132:135], v[80:95]
  v_mfma_f32_32x32x16_bf16 v[96:111], v[140:143], v[128:131], v[96:111]
  v_mfma_f32_32x32x16_bf16 v[112:127], v[140:143], v[132:135], v[112:127]
  s_lshr_b32 s20, s13, 3
  s_lshl1_add_u32 s20, s14, s20
  s_lshl_b32 s32, s18, 12
  s_lshl_b32 s35, s12, 12
  s_mul_i32 s23, s20, 221184
  s_add_u32 s24, s4, s23
  s_addc_u32 s25, s5, 0
  s_mov_b32 s26, 221184
  s_mov_b32 s27, 0x00020000
  v_min_u32 v3, 13, v2
  v_add_u32 v3, s71, v3
  v_subrev_u32 v1, 14, v3
  v_min_u32 v3, v1, v3
  v_lshlrev_b32 v3, 2, v3
  s_lshl_b32 s22, s14, 4
  s_add_u32 s22, s22, s13
  s_lshl_b32 s22, s22, 8
  s_add_u32 s22, s22, 131072
  s_xor_b32 s23, s12, 0
  s_lshl_b32 s23, s23, 10
  v_add_u32 v6, s23, v4
  s_xor_b32 s23, s12, 1
  s_lshl_b32 s23, s23, 10
  v_add_u32 v7, s23, v4
  s_xor_b32 s23, s12, 2
  s_lshl_b32 s23, s23, 10
  v_add_u32 v8, s23, v4
  s_xor_b32 s23, s12, 3
  s_lshl_b32 s23, s23, 10
  v_add_u32 v9, s23, v4
  s_cmp_eq_u32 s64, 2
  s_cselect_b32 s66, 0, 1
  s_bitcmp1_b32 s3, 9
  s_cselect_b32 s66, s66, -1
  v_mul_f32 v144, 0xc0135761, v162
  v_mul_f32 v145, v162, v162
  v_rcp_f32 v146, v162
  v_mul_f32 v145, v145, v144
  v_mul_f32 v145, 0x3d372713, v145
  v_mul_f32 v148, 0xc0135761, v166
  v_mul_f32 v149, v166, v166
  v_rcp_f32 v150, v166
  v_mul_f32 v149, v149, v148
  v_mul_f32 v149, 0x3d372713, v149
  s_waitcnt lgkmcnt(0)
  s_barrier
  s_cmp_lg_u32 s64, 0
  s_cbranch_scc1 L_g2wp
  v_mul_f32 v24, v64, v64
  v_mul_f32 v25, v65, v65
  v_mul_f32 v26, v66, v66
  v_mul_f32 v27, v67, v67
  v_mul_f32 v28, v68, v68
  v_mul_f32 v29, v69, v69
  v_mul_f32 v30, v70, v70
  v_mul_f32 v31, v71, v71
  v_fma_f32 v24, v24, v145, v144
  v_fma_f32 v25, v25, v145, v144
  v_fma_f32 v26, v26, v145, v144
  v_fma_f32 v27, v27, v145, v144
  v_fma_f32 v28, v28, v145, v144
  v_fma_f32 v29, v29, v145, v144
  v_fma_f32 v30, v30, v145, v144
  v_fma_f32 v31, v31, v145, v144
  v_mul_f32 v24, v24, v64
  v_mul_f32 v25, v25, v65
  v_mul_f32 v26, v26, v66
  buffer_load_dwordx4 v[196:199], v4, s[36:39], s33 offen offset:0
  v_mul_f32 v27, v27, v67
  v_mul_f32 v28, v28, v68
  v_mul_f32 v29, v29, v69
  v_mul_f32 v30, v30, v70
  v_mul_f32 v31, v31, v71
  v_exp_f32 v24, v24
  v_exp_f32 v25, v25
  v_exp_f32 v26, v26
  v_exp_f32 v27, v27
  v_exp_f32 v28, v28
  v_exp_f32 v29, v29
  v_exp_f32 v30, v30
  v_exp_f32 v31, v31
  v_fma_f32 v24, v24, v146, v146
  v_fma_f32 v25, v25, v146, v146
  v_fma_f32 v26, v26, v146, v146
  v_fma_f32 v27, v27, v146, v146
  v_fma_f32 v28, v28, v146, v146
  v_fma_f32 v29, v29, v146, v146
  buffer_load_dwordx4 v[200:203], v4, s[36:39], s33 offen offset:1024
  v_fma_f32 v30, v30, v146, v146
  v_fma_f32 v31, v31, v146, v146
  v_rcp_f32 v24, v24
  v_rcp_f32 v25, v25
  v_rcp_f32 v26, v26
  v_rcp_f32 v27, v27
  v_rcp_f32 v28, v28
  v_rcp_f32 v29, v29
  v_rcp_f32 v30, v30
  v_rcp_f32 v31, v31
  v_mul_f32 v64, v64, v24
  v_mul_f32 v65, v65, v25
  v_mul_f32 v66, v66, v26
  v_mul_f32 v67, v67, v27
  v_mul_f32 v68, v68, v28
  v_mul_f32 v69, v69, v29
  v_mul_f32 v70, v70, v30
  v_mul_f32 v71, v71, v31
  v_cvt_pk_bf16_f32 v64, v64, v65
  buffer_load_dwordx4 v[204:207], v4, s[36:39], s33 offen offset:2048
  v_cvt_pk_bf16_f32 v65, v66, v67
  v_cvt_pk_bf16_f32 v66, v68, v69
  v_cvt_pk_bf16_f32 v67, v70, v71
  buffer_store_dwordx4 v[64:67], v12, s[44:47], s62 offen offset:0 sc1
  v_mul_f32 v32, v72, v72
  v_mul_f32 v33, v73, v73
  v_mul_f32 v34, v74, v74
  v_mul_f32 v35, v75, v75
  v_mul_f32 v36, v76, v76
  v_mul_f32 v37, v77, v77
  v_mul_f32 v38, v78, v78
  v_mul_f32 v39, v79, v79
  v_fma_f32 v32, v32, v145, v144
  v_fma_f32 v33, v33, v145, v144
  v_fma_f32 v34, v34, v145, v144
  v_fma_f32 v35, v35, v145, v144
  v_fma_f32 v36, v36, v145, v144
  v_fma_f32 v37, v37, v145, v144
  v_fma_f32 v38, v38, v145, v144
  buffer_load_dwordx4 v[208:211], v4, s[36:39], s33 offen offset:3072
  v_fma_f32 v39, v39, v145, v144
  v_mul_f32 v32, v32, v72
  v_mul_f32 v33, v33, v73
  v_mul_f32 v34, v34, v74
  v_mul_f32 v35, v35, v75
  v_mul_f32 v36, v36, v76
  v_mul_f32 v37, v37, v77
  v_mul_f32 v38, v38, v78
  v_mul_f32 v39, v39, v79
  v_exp_f32 v32, v32
  v_exp_f32 v33, v33
  v_exp_f32 v34, v34
  v_exp_f32 v35, v35
  v_exp_f32 v36, v36
  v_exp_f32 v37, v37
  v_exp_f32 v38, v38
  v_exp_f32 v39, v39
  v_fma_f32 v32, v32, v146, v146
  v_fma_f32 v33, v33, v146, v146
  buffer_load_dwordx4 v[212:215], v5, s[36:39], s33 offen
  s_add_u32 s33, s33, 40960
  s_cmp_ge_u32 s33, 286720
  s_cselect_b32 s19, 286720, 0
  s_sub_u32 s33, s33, s19
  v_fma_f32 v34, v34, v146, v146
  v_fma_f32 v35, v35, v146, v146
  v_fma_f32 v36, v36, v146, v146
  v_fma_f32 v37, v37, v146, v146
  v_fma_f32 v38, v38, v146, v146
  v_fma_f32 v39, v39, v146, v146
  v_rcp_f32 v32, v32
  v_rcp_f32 v33, v33
  v_rcp_f32 v34, v34
  v_rcp_f32 v35, v35
  v_rcp_f32 v36, v36
  v_rcp_f32 v37, v37
  v_rcp_f32 v38, v38
  v_rcp_f32 v39, v39
  v_mul_f32 v72, v72, v32
  v_mul_f32 v73, v73, v33
  v_mul_f32 v74, v74, v34
  v_mul_f32 v75, v75, v35
  v_mul_f32 v76, v76, v36
  s_add_u32 m0, s35, 65536
  s_nop 0
  buffer_load_dwordx4 v5, s[36:39], s40 offen  lds
  v_mul_f32 v77, v77, v37
  v_mul_f32 v78, v78, v38
  v_mul_f32 v79, v79, v39
  v_cvt_pk_bf16_f32 v72, v72, v73
  v_cvt_pk_bf16_f32 v73, v74, v75
  v_cvt_pk_bf16_f32 v74, v76, v77
  v_cvt_pk_bf16_f32 v75, v78, v79
  buffer_store_dwordx4 v[72:75], v12, s[44:47], s62 offen offset:512 sc1
  v_mul_f32 v24, v80, v80
  v_mul_f32 v25, v81, v81
  v_mul_f32 v26, v82, v82
  v_mul_f32 v27, v83, v83
  v_mul_f32 v28, v84, v84
  v_mul_f32 v29, v85, v85
  v_mul_f32 v30, v86, v86
  v_mul_f32 v31, v87, v87
  v_fma_f32 v24, v24, v149, v148
  v_fma_f32 v25, v25, v149, v148
  v_fma_f32 v26, v26, v149, v148
  s_add_u32 m0, s35, 66560
  s_nop 0
  buffer_load_dwordx4 v5, s[36:39], s41 offen  lds
  v_fma_f32 v27, v27, v149, v148
  v_fma_f32 v28, v28, v149, v148
  v_fma_f32 v29, v29, v149, v148
  v_fma_f32 v30, v30, v149, v148
  v_fma_f32 v31, v31, v149, v148
  v_mul_f32 v24, v24, v80
  v_mul_f32 v25, v25, v81
  v_mul_f32 v26, v26, v82
  v_mul_f32 v27, v27, v83
  v_mul_f32 v28, v28, v84
  v_mul_f32 v29, v29, v85
  v_mul_f32 v30, v30, v86
  v_mul_f32 v31, v31, v87
  v_exp_f32 v24, v24
  v_exp_f32 v25, v25
  v_exp_f32 v26, v26
  v_exp_f32 v27, v27
  v_exp_f32 v28, v28
  v_exp_f32 v29, v29
  s_add_u32 m0, s35, 67584
  s_nop 0
  buffer_load_dwordx4 v5, s[36:39], s42 offen  lds
  v_exp_f32 v30, v30
  v_exp_f32 v31, v31
  v_fma_f32 v24, v24, v150, v150
  v_fma_f32 v25, v25, v150, v150
  v_fma_f32 v26, v26, v150, v150
  v_fma_f32 v27, v27, v150, v150
  v_fma_f32 v28, v28, v150, v150
  v_fma_f32 v29, v29, v150, v150
  v_fma_f32 v30, v30, v150, v150
  v_fma_f32 v31, v31, v150, v150
  v_rcp_f32 v24, v24
  v_rcp_f32 v25, v25
  v_rcp_f32 v26, v26
  v_rcp_f32 v27, v27
  v_rcp_f32 v28, v28
  v_rcp_f32 v29, v29
  v_rcp_f32 v30, v30
  v_rcp_f32 v31, v31
  v_mul_f32 v80, v80, v24
  s_add_u32 m0, s35, 68608
  s_nop 0
  buffer_load_dwordx4 v5, s[36:39], s43 offen  lds
  v_mul_f32 v81, v81, v25
  v_mul_f32 v82, v82, v26
  v_mul_f32 v83, v83, v27
  v_mul_f32 v84, v84, v28
  v_mul_f32 v85, v85, v29
  v_mul_f32 v86, v86, v30
  v_mul_f32 v87, v87, v31
  v_cvt_pk_bf16_f32 v80, v80, v81
  v_cvt_pk_bf16_f32 v81, v82, v83
  v_cvt_pk_bf16_f32 v82, v84, v85
  v_cvt_pk_bf16_f32 v83, v86, v87
  buffer_store_dwordx4 v[80:83], v12, s[44:47], s62 offen offset:2048 sc1
  v_mul_f32 v32, v88, v88
  v_mul_f32 v33, v89, v89
  v_mul_f32 v34, v90, v90
  v_mul_f32 v35, v91, v91
  v_mul_f32 v36, v92, v92
  v_mul_f32 v37, v93, v93
  v_mul_f32 v38, v94, v94
  buffer_load_dwordx4 v[216:219], v4, s[36:39], s33 offen offset:0
  v_mul_f32 v39, v95, v95
  v_fma_f32 v32, v32, v149, v148
  v_fma_f32 v33, v33, v149, v148
  v_fma_f32 v34, v34, v149, v148
  v_fma_f32 v35, v35, v149, v148
  v_fma_f32 v36, v36, v149, v148
  v_fma_f32 v37, v37, v149, v148
  v_fma_f32 v38, v38, v149, v148
  v_fma_f32 v39, v39, v149, v148
  v_mul_f32 v32, v32, v88
  v_mul_f32 v33, v33, v89
  v_mul_f32 v34, v34, v90
  v_mul_f32 v35, v35, v91
  v_mul_f32 v36, v36, v92
  v_mul_f32 v37, v37, v93
  v_mul_f32 v38, v38, v94
  v_mul_f32 v39, v39, v95
  v_exp_f32 v32, v32
  v_exp_f32 v33, v33
  buffer_load_dwordx4 v[220:223], v4, s[36:39], s33 offen offset:1024
  v_exp_f32 v34, v34
  v_exp_f32 v35, v35
  v_exp_f32 v36, v36
  v_exp_f32 v37, v37
  v_exp_f32 v38, v38
  v_exp_f32 v39, v39
  v_fma_f32 v32, v32, v150, v150
  v_fma_f32 v33, v33, v150, v150
  v_fma_f32 v34, v34, v150, v150
  v_fma_f32 v35, v35, v150, v150
  v_fma_f32 v36, v36, v150, v150
  v_fma_f32 v37, v37, v150, v150
  v_fma_f32 v38, v38, v150, v150
  v_fma_f32 v39, v39, v150, v150
  v_rcp_f32 v32, v32
  v_rcp_f32 v33, v33
  v_rcp_f32 v34, v34
  v_rcp_f32 v35, v35
  v_rcp_f32 v36, v36
  buffer_load_dwordx4 v[224:227], v4, s[36:39], s33 offen offset:2048
  v_rcp_f32 v37, v37
  v_rcp_f32 v38, v38
  v_rcp_f32 v39, v39
  v_mul_f32 v88, v88, v32
  v_mul_f32 v89, v89, v33
  v_mul_f32 v90, v90, v34
  v_mul_f32 v91, v91, v35
  v_mul_f32 v92, v92, v36
  v_mul_f32 v93, v93, v37
  v_mul_f32 v94, v94, v38
  v_mul_f32 v95, v95, v39
  v_cvt_pk_bf16_f32 v88, v88, v89
  v_cvt_pk_bf16_f32 v89, v90, v91
  v_cvt_pk_bf16_f32 v90, v92, v93
  v_cvt_pk_bf16_f32 v91, v94, v95
  buffer_store_dwordx4 v[88:91], v12, s[44:47], s62 offen offset:2560 sc1
  v_mul_f32 v24, v96, v96
  v_mul_f32 v25, v97, v97
  v_mul_f32 v26, v98, v98
  buffer_load_dwordx4 v[228:231], v4, s[36:39], s33 offen offset:3072
  v_mul_f32 v27, v99, v99
  v_mul_f32 v28, v100, v100
  v_mul_f32 v29, v101, v101
  v_mul_f32 v30, v102, v102
  v_mul_f32 v31, v103, v103
  v_fma_f32 v24, v24, v145, v144
  v_fma_f32 v25, v25, v145, v144
  v_fma_f32 v26, v26, v145, v144
  v_fma_f32 v27, v27, v145, v144
  v_fma_f32 v28, v28, v145, v144
  v_fma_f32 v29, v29, v145, v144
  v_fma_f32 v30, v30, v145, v144
  v_fma_f32 v31, v31, v145, v144
  v_mul_f32 v24, v24, v96
  v_mul_f32 v25, v25, v97
  v_mul_f32 v26, v26, v98
  v_mul_f32 v27, v27, v99
  v_mul_f32 v28, v28, v100
  v_mul_f32 v29, v29, v101
  buffer_load_dwordx4 v[232:235], v5, s[36:39], s33 offen
  s_add_u32 s33, s33, 40960
  s_cmp_ge_u32 s33, 286720
  s_cselect_b32 s19, 286720, 0
  s_sub_u32 s33, s33, s19
  v_mul_f32 v30, v30, v102
  v_mul_f32 v31, v31, v103
  v_exp_f32 v24, v24
  v_exp_f32 v25, v25
  v_exp_f32 v26, v26
  v_exp_f32 v27, v27
  v_exp_f32 v28, v28
  v_exp_f32 v29, v29
  v_exp_f32 v30, v30
  v_exp_f32 v31, v31
  v_fma_f32 v24, v24, v146, v146
  v_fma_f32 v25, v25, v146, v146
  v_fma_f32 v26, v26, v146, v146
  v_fma_f32 v27, v27, v146, v146
  v_fma_f32 v28, v28, v146, v146
  v_fma_f32 v29, v29, v146, v146
  v_fma_f32 v30, v30, v146, v146
  v_fma_f32 v31, v31, v146, v146
  v_rcp_f32 v24, v24
  buffer_load_dwordx4 v[236:239], v4, s[36:39], s33 offen offset:0
  v_rcp_f32 v25, v25
  v_rcp_f32 v26, v26
  v_rcp_f32 v27, v27
  v_rcp_f32 v28, v28
  v_rcp_f32 v29, v29
  v_rcp_f32 v30, v30
  v_rcp_f32 v31, v31
  v_mul_f32 v96, v96, v24
  v_mul_f32 v97, v97, v25
  v_mul_f32 v98, v98, v26
  v_mul_f32 v99, v99, v27
  v_mul_f32 v100, v100, v28
  v_mul_f32 v101, v101, v29
  v_mul_f32 v102, v102, v30
  v_mul_f32 v103, v103, v31
  v_cvt_pk_bf16_f32 v96, v96, v97
  v_cvt_pk_bf16_f32 v97, v98, v99
  v_cvt_pk_bf16_f32 v98, v100, v101
  v_cvt_pk_bf16_f32 v99, v102, v103
  buffer_load_dwordx4 v[240:243], v4, s[36:39], s33 offen offset:1024
  buffer_store_dwordx4 v[96:99], v12, s[44:47], s63 offen offset:0 sc1
  v_mul_f32 v32, v104, v104
  v_mul_f32 v33, v105, v105
  v_mul_f32 v34, v106, v106
  v_mul_f32 v35, v107, v107
  v_mul_f32 v36, v108, v108
  v_mul_f32 v37, v109, v109
  v_mul_f32 v38, v110, v110
  v_mul_f32 v39, v111, v111
  v_fma_f32 v32, v32, v145, v144
  v_fma_f32 v33, v33, v145, v144
  v_fma_f32 v34, v34, v145, v144
  v_fma_f32 v35, v35, v145, v144
  v_fma_f32 v36, v36, v145, v144
  v_fma_f32 v37, v37, v145, v144
  v_fma_f32 v38, v38, v145, v144
  v_fma_f32 v39, v39, v145, v144
  v_mul_f32 v32, v32, v104
  v_mul_f32 v33, v33, v105
  buffer_load_dwordx4 v[244:247], v4, s[36:39], s33 offen offset:2048
  v_mul_f32 v34, v34, v106
  v_mul_f32 v35, v35, v107
  v_mul_f32 v36, v36, v108
  v_mul_f32 v37, v37, v109
  v_mul_f32 v38, v38, v110
  v_mul_f32 v39, v39, v111
  v_exp_f32 v32, v32
  v_exp_f32 v33, v33
  v_exp_f32 v34, v34
  v_exp_f32 v35, v35
  v_exp_f32 v36, v36
  v_exp_f32 v37, v37
  v_exp_f32 v38, v38
  v_exp_f32 v39, v39
  v_fma_f32 v32, v32, v146, v146
  v_fma_f32 v33, v33, v146, v146
  v_fma_f32 v34, v34, v146, v146
  v_fma_f32 v35, v35, v146, v146
  v_fma_f32 v36, v36, v146, v146
  buffer_load_dwordx4 v[248:251], v4, s[36:39], s33 offen offset:3072
  v_fma_f32 v37, v37, v146, v146
  v_fma_f32 v38, v38, v146, v146
  v_fma_f32 v39, v39, v146, v146
  v_rcp_f32 v32, v32
  v_rcp_f32 v33, v33
  v_rcp_f32 v34, v34
  v_rcp_f32 v35, v35
  v_rcp_f32 v36, v36
  v_rcp_f32 v37, v37
  v_rcp_f32 v38, v38
  v_rcp_f32 v39, v39
  v_mul_f32 v104, v104, v32
  v_mul_f32 v105, v105, v33
  v_mul_f32 v106, v106, v34
  v_mul_f32 v107, v107, v35
  v_mul_f32 v108, v108, v36
  v_mul_f32 v109, v109, v37
  v_mul_f32 v110, v110, v38
  v_mul_f32 v111, v111, v39
  buffer_load_dwordx4 v[252:255], v5, s[36:39], s33 offen
  s_add_u32 s33, s33, 40960
  s_cmp_ge_u32 s33, 286720
  s_cselect_b32 s19, 286720, 0
  s_sub_u32 s33, s33, s19
  v_cvt_pk_bf16_f32 v104, v104, v105
  v_cvt_pk_bf16_f32 v105, v106, v107
  v_cvt_pk_bf16_f32 v106, v108, v109
  v_cvt_pk_bf16_f32 v107, v110, v111
  buffer_store_dwordx4 v[104:107], v12, s[44:47], s63 offen offset:512 sc1
  v_mul_f32 v24, v112, v112
  v_mul_f32 v25, v113, v113
  v_mul_f32 v26, v114, v114
  v_mul_f32 v27, v115, v115
  v_mul_f32 v28, v116, v116
  v_mul_f32 v29, v117, v117
  v_mul_f32 v30, v118, v118
  v_mul_f32 v31, v119, v119
  v_fma_f32 v24, v24, v149, v148
  v_fma_f32 v25, v25, v149, v148
  v_fma_f32 v26, v26, v149, v148
  v_fma_f32 v27, v27, v149, v148
  v_fma_f32 v28, v28, v149, v148
  v_fma_f32 v29, v29, v149, v148
  v_fma_f32 v30, v30, v149, v148
  v_fma_f32 v31, v31, v149, v148
  v_mul_f32 v24, v24, v112
  v_mul_f32 v25, v25, v113
  v_mul_f32 v26, v26, v114
  v_mul_f32 v27, v27, v115
  v_mul_f32 v28, v28, v116
  v_mul_f32 v29, v29, v117
  v_mul_f32 v30, v30, v118
  v_mul_f32 v31, v31, v119
  v_exp_f32 v24, v24
  v_exp_f32 v25, v25
  v_exp_f32 v26, v26
  v_exp_f32 v27, v27
  v_exp_f32 v28, v28
  v_exp_f32 v29, v29
  v_exp_f32 v30, v30
  v_exp_f32 v31, v31
  v_fma_f32 v24, v24, v150, v150
  v_fma_f32 v25, v25, v150, v150
  v_fma_f32 v26, v26, v150, v150
  v_fma_f32 v27, v27, v150, v150
  v_fma_f32 v28, v28, v150, v150
  v_fma_f32 v29, v29, v150, v150
  v_fma_f32 v30, v30, v150, v150
  v_fma_f32 v31, v31, v150, v150
  v_rcp_f32 v24, v24
  v_rcp_f32 v25, v25
  v_rcp_f32 v26, v26
  v_rcp_f32 v27, v27
  v_rcp_f32 v28, v28
  v_rcp_f32 v29, v29
  v_rcp_f32 v30, v30
  v_rcp_f32 v31, v31
  v_mul_f32 v112, v112, v24
  v_mul_f32 v113, v113, v25
  v_mul_f32 v114, v114, v26
  v_mul_f32 v115, v115, v27
  v_mul_f32 v116, v116, v28
  v_mul_f32 v117, v117, v29
  v_mul_f32 v118, v118, v30
  v_mul_f32 v119, v119, v31
  v_cvt_pk_bf16_f32 v112, v112, v113
  v_cvt_pk_bf16_f32 v113, v114, v115
  v_cvt_pk_bf16_f32 v114, v116, v117
  v_cvt_pk_bf16_f32 v115, v118, v119
  buffer_store_dwordx4 v[112:115], v12, s[44:47], s63 offen offset:2048 sc1
  v_mul_f32 v32, v120, v120
  v_mul_f32 v33, v121, v121
  v_mul_f32 v34, v122, v122
  v_mul_f32 v35, v123, v123
  v_mul_f32 v36, v124, v124
  v_mul_f32 v37, v125, v125
  v_mul_f32 v38, v126, v126
  v_mul_f32 v39, v127, v127
  v_fma_f32 v32, v32, v149, v148
  v_fma_f32 v33, v33, v149, v148
  v_fma_f32 v34, v34, v149, v148
  v_fma_f32 v35, v35, v149, v148
  v_fma_f32 v36, v36, v149, v148
  v_fma_f32 v37, v37, v149, v148
  v_fma_f32 v38, v38, v149, v148
  v_fma_f32 v39, v39, v149, v148
  v_mul_f32 v32, v32, v120
  v_mul_f32 v33, v33, v121
  v_mul_f32 v34, v34, v122
  v_mul_f32 v35, v35, v123
  v_mul_f32 v36, v36, v124
  v_mul_f32 v37, v37, v125
  v_mul_f32 v38, v38, v126
  v_mul_f32 v39, v39, v127
  v_exp_f32 v32, v32
  v_exp_f32 v33, v33
  v_exp_f32 v34, v34
  v_exp_f32 v35, v35
  v_exp_f32 v36, v36
  v_exp_f32 v37, v37
  v_exp_f32 v38, v38
  v_exp_f32 v39, v39
  v_fma_f32 v32, v32, v150, v150
  v_fma_f32 v33, v33, v150, v150
  v_fma_f32 v34, v34, v150, v150
  v_fma_f32 v35, v35, v150, v150
  v_fma_f32 v36, v36, v150, v150
  v_fma_f32 v37, v37, v150, v150
  v_fma_f32 v38, v38, v150, v150
  v_fma_f32 v39, v39, v150, v150
  v_rcp_f32 v32, v32
  v_rcp_f32 v33, v33
  v_rcp_f32 v34, v34
  v_rcp_f32 v35, v35
  v_rcp_f32 v36, v36
  v_rcp_f32 v37, v37
  v_rcp_f32 v38, v38
  v_rcp_f32 v39, v39
  v_mul_f32 v120, v120, v32
  v_mul_f32 v121, v121, v33
  v_mul_f32 v122, v122, v34
  v_mul_f32 v123, v123, v35
  v_mul_f32 v124, v124, v36
  v_mul_f32 v125, v125, v37
  v_mul_f32 v126, v126, v38
  v_mul_f32 v127, v127, v39
  v_cvt_pk_bf16_f32 v120, v120, v121
  v_cvt_pk_bf16_f32 v121, v122, v123
  v_cvt_pk_bf16_f32 v122, v124, v125
  v_cvt_pk_bf16_f32 v123, v126, v127
  buffer_store_dwordx4 v[120:123], v12, s[44:47], s63 offen offset:2560 sc1
L_g1_skip:
  s_waitcnt vmcnt(0)
  s_barrier
  s_branch R_G2M
L_g2wq:
  s_add_u32 s34, s34, 20480
  s_cmp_ge_u32 s34, 286720
  s_cselect_b32 s19, 286720, 0
  s_sub_u32 s34, s34, s19
  s_add_u32 m0, s35, 0
  s_min_u32 s90, s34, 271360
  buffer_load_dwordx4 v4, s[36:39], s90 offen offset:0  lds
  buffer_load_dwordx4 v4, s[36:39], s90 offen offset:1024  lds
  buffer_load_dwordx4 v4, s[36:39], s90 offen offset:2048  lds
  buffer_load_dwordx4 v4, s[36:39], s90 offen offset:3072  lds
  s_mov_b32 s40, s90
  s_add_u32 s34, s34, 40960
  s_cmp_ge_u32 s34, 286720
  s_cselect_b32 s19, 286720, 0
  s_sub_u32 s34, s34, s19
  s_add_u32 m0, s35, 16384
  s_min_u32 s90, s34, 271360
  buffer_load_dwordx4 v4, s[36:39], s90 offen offset:0  lds
  buffer_load_dwordx4 v4, s[36:39], s90 offen offset:1024  lds
  buffer_load_dwordx4 v4, s[36:39], s90 offen offset:2048  lds
  buffer_load_dwordx4 v4, s[36:39], s90 offen offset:3072  lds
  s_mov_b32 s41, s90
  s_add_u32 s34, s34, 40960
  s_cmp_ge_u32 s34, 286720
  s_cselect_b32 s19, 286720, 0
  s_sub_u32 s34, s34, s19
  s_add_u32 m0, s35, 32768
  s_min_u32 s90, s34, 271360
  buffer_load_dwordx4 v4, s[36:39], s90 offen offset:0  lds
  buffer_load_dwordx4 v4, s[36:39], s90 offen offset:1024  lds
  buffer_load_dwordx4 v4, s[36:39], s90 offen offset:2048  lds
  buffer_load_dwordx4 v4, s[36:39], s90 offen offset:3072  lds
  s_mov_b32 s42, s90
  s_add_u32 s34, s34, 40960
  s_cmp_ge_u32 s34, 286720
  s_cselect_b32 s19, 286720, 0
  s_sub_u32 s34, s34, s19
  s_add_u32 m0, s35, 49152
  s_min_u32 s90, s34, 271360
  buffer_load_dwordx4 v4, s[36:39], s90 offen offset:0  lds
  buffer_load_dwordx4 v4, s[36:39], s90 offen offset:1024  lds
  buffer_load_dwordx4 v4, s[36:39], s90 offen offset:2048  lds
  buffer_load_dwordx4 v4, s[36:39], s90 offen offset:3072  lds
  s_mov_b32 s43, s90
L_g2wp:
  buffer_load_dwordx4 v[196:199], v4, s[36:39], s33 offen offset:0
  buffer_load_dwordx4 v[200:203], v4, s[36:39], s33 offen offset:1024
  buffer_load_dwordx4 v[204:207], v4, s[36:39], s33 offen offset:2048
  buffer_load_dwordx4 v[208:211], v4, s[36:39], s33 offen offset:3072
  buffer_load_dwordx4 v[212:215], v5, s[36:39], s33 offen
  s_add_u32 s33, s33, 40960
  s_cmp_ge_u32 s33, 286720
  s_cselect_b32 s19, 286720, 0
  s_sub_u32 s33, s33, s19
  s_add_u32 m0, s35, 65536
  s_nop 0
  buffer_load_dwordx4 v5, s[36:39], s40 offen  lds
  s_add_u32 m0, s35, 66560
  s_nop 0
  buffer_load_dwordx4 v5, s[36:39], s41 offen  lds
  s_add_u32 m0, s35, 67584
  s_nop 0
  buffer_load_dwordx4 v5, s[36:39], s42 offen  lds
  s_add_u32 m0, s35, 68608
  s_nop 0
  buffer_load_dwordx4 v5, s[36:39], s43 offen  lds
  buffer_load_dwordx4 v[216:219], v4, s[36:39], s33 offen offset:0
  buffer_load_dwordx4 v[220:223], v4, s[36:39], s33 offen offset:1024
  buffer_load_dwordx4 v[224:227], v4, s[36:39], s33 offen offset:2048
  buffer_load_dwordx4 v[228:231], v4, s[36:39], s33 offen offset:3072
  buffer_load_dwordx4 v[232:235], v5, s[36:39], s33 offen
  s_add_u32 s33, s33, 40960
  s_cmp_ge_u32 s33, 286720
  s_cselect_b32 s19, 286720, 0
  s_sub_u32 s33, s33, s19
  buffer_load_dwordx4 v[236:239], v4, s[36:39], s33 offen offset:0
  buffer_load_dwordx4 v[240:243], v4, s[36:39], s33 offen offset:1024
  buffer_load_dwordx4 v[244:247], v4, s[36:39], s33 offen offset:2048
  buffer_load_dwordx4 v[248:251], v4, s[36:39], s33 offen offset:3072
  buffer_load_dwordx4 v[252:255], v5, s[36:39], s33 offen
  s_add_u32 s33, s33, 40960
  s_cmp_ge_u32 s33, 286720
  s_cselect_b32 s19, 286720, 0
  s_sub_u32 s33, s33, s19
  s_cmp_eq_u32 s64, 1
  s_cbranch_scc1 L_g1_skip
R_G2M:
  s_setprio 1
  s_bitcmp1_b32 s66, 0
  s_cbranch_scc1 Lhr_3
  s_mov_b32 s67, 0
  s_call_b64 s[68:69], L_g2spin
Lhr_3:
  buffer_load_dwordx4 v[96:99], v6, s[24:27], s32 offen
  buffer_load_dwordx4 v[100:103], v7, s[24:27], s32 offen
  buffer_load_dwordx4 v[104:107], v8, s[24:27], s32 offen
  buffer_load_dwordx4 v[108:111], v9, s[24:27], s32 offen
  s_add_u32 s32, s32, 16384
  s_cmp_ge_u32 s32, 229376
  s_cselect_b32 s19, 229376, 0
  s_sub_u32 s32, s32, s19
  s_lshr_b32 s19, s64, 1
  s_or_b32 s19, s19, s12
  v_mov_b32 v62, s15
  s_cmp_eq_u32 s19, 0
  s_cselect_b32 exec_lo, 0x1ffff, 0
  s_mov_b32 exec_hi, 0
  buffer_store_dword v62, v63, s[8:11], s67 offen sc1
  s_mov_b64 exec, -1
  buffer_load_dword v1, v3, s[8:11], s22 offen sc1
  s_mov_b32 s28, s16
  s_mov_b32 s29, s17
  s_mov_b32 s30, 2621440
  s_mov_b32 s31, 0x00020000
  s_mov_b32 s40, s100
  s_mov_b32 s41, s101
  s_mov_b32 s42, 2621440
  s_mov_b32 s43, 0x00020000
  s_mov_b32 s44, s54
  s_mov_b32 s45, s55
  s_mov_b32 s46, 1280
  s_mov_b32 s47, 0x00020000
  s_add_u32 s48, s4, 16777216
  s_addc_u32 s49, s5, 0
  s_mov_b32 s50, 2621440
  s_mov_b32 s51, 0x00020000
  v_and_b32 v10, 15, v2
  v_lshrrev_b32 v11, 4, v2
  s_lshl_b32 s23, s20, 6
  s_lshl_b32 s57, s12, 4
  s_add_u32 s23, s23, s57
  s_mul_i32 s57, s21, 160
  v_lshl_add_u32 v12, v11, 3, s57
  v_add_u32 v13, s23, v10
  v_mul_u32_u24 v13, 1280, v13
  v_add_u32 v13, v13, v12
  v_add_u32 v15, s35, v4
  v_add_u32 v0, 65536, v15
  v_lshrrev_b32 v14, 1, v2
  v_lshlrev_b32 v14, 12, v14
  v_and_b32 v10, 1, v2
  v_lshl_add_u32 v14, v10, 4, v14
  s_mul_i32 s57, s21, 327680
  s_lshl_b32 s23, s23, 1
  s_add_u32 s57, s57, s23
  s_add_u32 s56, s35, 49152
  v_min_u32 v11, 26, v2
  v_lshlrev_b32 v11, 2, v11
  s_add_u32 s58, s22, 128
  s_waitcnt vmcnt(2)
  ds_read_b128 v[176:179], v15 offset:0
  ds_read_b128 v[180:183], v15 offset:1024
  ds_read_b128 v[184:187], v15 offset:2048
  ds_read_b128 v[188:191], v15 offset:3072
  ds_read_b128 v[192:195], v0 offset:0
  v_mfma_f32_16x16x32_bf16 v[16:19], v[196:199], v[96:99], 0
  v_mfma_f32_16x16x32_bf16 v[20:23], v[196:199], v[100:103], 0
  v_mfma_f32_16x16x32_bf16 v[24:27], v[196:199], v[104:107], 0
  v_mfma_f32_16x16x32_bf16 v[28:31], v[196:199], v[108:111], 0
  v_mfma_f32_16x16x32_bf16 v[32:35], v[200:203], v[96:99], 0
  v_mfma_f32_16x16x32_bf16 v[36:39], v[200:203], v[100:103], 0
  v_mfma_f32_16x16x32_bf16 v[40:43], v[200:203], v[104:107], 0
  v_mfma_f32_16x16x32_bf16 v[44:47], v[200:203], v[108:111], 0
  v_mfma_f32_16x16x32_bf16 v[48:51], v[204:207], v[96:99], 0
  v_mfma_f32_16x16x32_bf16 v[52:55], v[204:207], v[100:103], 0
  v_mfma_f32_16x16x32_bf16 v[56:59], v[204:207], v[104:107], 0
  v_mfma_f32_16x16x32_bf16 v[60:63], v[204:207], v[108:111], 0
  v_mfma_f32_16x16x32_bf16 v[64:67], v[208:211], v[96:99], 0
  v_mfma_f32_16x16x32_bf16 v[68:71], v[208:211], v[100:103], 0
  v_mfma_f32_16x16x32_bf16 v[72:75], v[208:211], v[104:107], 0
  v_mfma_f32_16x16x32_bf16 v[76:79], v[208:211], v[108:111], 0
  v_mfma_f32_16x16x32_bf16 v[80:83], v[212:215], v[96:99], 0
  v_mfma_f32_16x16x32_bf16 v[84:87], v[212:215], v[100:103], 0
  v_mfma_f32_16x16x32_bf16 v[88:91], v[212:215], v[104:107], 0
  v_mfma_f32_16x16x32_bf16 v[92:95], v[212:215], v[108:111], 0
  s_waitcnt vmcnt(0)
  v_cmp_eq_u32 vcc, s15, v1
  s_nop 0
  s_or_b32 s66, s66, vcc_lo
  s_bitcmp1_b32 s66, 1
  s_cbranch_scc1 Lhr_4
  s_mov_b32 s67, 1
  s_call_b64 s[68:69], L_g2spin
Lhr_4:
  buffer_load_dwordx4 v[112:115], v6, s[24:27], s32 offen
  buffer_load_dwordx4 v[116:119], v7, s[24:27], s32 offen
  buffer_load_dwordx4 v[120:123], v8, s[24:27], s32 offen
  buffer_load_dwordx4 v[124:127], v9, s[24:27], s32 offen
  s_add_u32 s32, s32, 16384
  s_cmp_ge_u32 s32, 229376
  s_cselect_b32 s19, 229376, 0
  s_sub_u32 s32, s32, s19
  s_bitcmp1_b32 s66, 2
  s_cbranch_scc1 Lhr_5
  s_mov_b32 s67, 2
  s_call_b64 s[68:69], L_g2spin
Lhr_5:
  buffer_load_dwordx4 v[128:131], v6, s[24:27], s32 offen
  buffer_load_dwordx4 v[132:135], v7, s[24:27], s32 offen
  buffer_load_dwordx4 v[136:139], v8, s[24:27], s32 offen
  buffer_load_dwordx4 v[140:143], v9, s[24:27], s32 offen
  s_add_u32 s32, s32, 16384
  s_cmp_ge_u32 s32, 229376
  s_cselect_b32 s19, 229376, 0
  s_sub_u32 s32, s32, s19
  s_bitcmp1_b32 s66, 3
  s_cbranch_scc1 Lhr_6
  s_mov_b32 s67, 3
  s_call_b64 s[68:69], L_g2spin
Lhr_6:
  buffer_load_dwordx4 v[144:147], v6, s[24:27], s32 offen
  buffer_load_dwordx4 v[148:151], v7, s[24:27], s32 offen
  buffer_load_dwordx4 v[152:155], v8, s[24:27], s32 offen
  buffer_load_dwordx4 v[156:159], v9, s[24:27], s32 offen
  s_add_u32 s32, s32, 16384
  s_cmp_ge_u32 s32, 229376
  s_cselect_b32 s19, 229376, 0
  s_sub_u32 s32, s32, s19
  s_bitcmp1_b32 s66, 4
  s_cbranch_scc1 Lhr_7
  s_mov_b32 s67, 4
  s_call_b64 s[68:69], L_g2spin
Lhr_7:
  buffer_load_dwordx4 v[160:163], v6, s[24:27], s32 offen
  buffer_load_dwordx4 v[164:167], v7, s[24:27], s32 offen
  buffer_load_dwordx4 v[168:171], v8, s[24:27], s32 offen
  buffer_load_dwordx4 v[172:175], v9, s[24:27], s32 offen
  s_add_u32 s32, s32, 16384
  s_cmp_ge_u32 s32, 229376
  s_cselect_b32 s19, 229376, 0
  s_sub_u32 s32, s32, s19
  buffer_load_dword v1, v3, s[8:11], s22 offen sc1
  s_waitcnt lgkmcnt(0)
  s_waitcnt vmcnt(13)
  s_bitcmp1_b32 s66, 5
  s_cbranch_scc1 Lhr_8
  s_mov_b32 s67, 5
  s_call_b64 s[68:69], L_g2spin
Lhr_8:
  v_mfma_f32_16x16x32_bf16 v[16:19], v[176:179], v[112:115], v[16:19]
  v_mfma_f32_16x16x32_bf16 v[20:23], v[176:179], v[116:119], v[20:23]
  buffer_load_dwordx4 v[96:99], v6, s[24:27], s32 offen
  v_mfma_f32_16x16x32_bf16 v[24:27], v[176:179], v[120:123], v[24:27]
  v_mfma_f32_16x16x32_bf16 v[28:31], v[176:179], v[124:127], v[28:31]
  buffer_load_dwordx4 v[100:103], v7, s[24:27], s32 offen
  v_mfma_f32_16x16x32_bf16 v[32:35], v[180:183], v[112:115], v[32:35]
  v_mfma_f32_16x16x32_bf16 v[36:39], v[180:183], v[116:119], v[36:39]
  buffer_load_dwordx4 v[104:107], v8, s[24:27], s32 offen
  v_mfma_f32_16x16x32_bf16 v[40:43], v[180:183], v[120:123], v[40:43]
  v_mfma_f32_16x16x32_bf16 v[44:47], v[180:183], v[124:127], v[44:47]
  buffer_load_dwordx4 v[108:111], v9, s[24:27], s32 offen
  s_add_u32 s32, s32, 16384
  s_cmp_ge_u32 s32, 229376
  s_cselect_b32 s19, 229376, 0
  s_sub_u32 s32, s32, s19
  v_mfma_f32_16x16x32_bf16 v[48:51], v[184:187], v[112:115], v[48:51]
  v_mfma_f32_16x16x32_bf16 v[52:55], v[184:187], v[116:119], v[52:55]
  buffer_load_dwordx4 v[196:199], v4, s[36:39], s33 offen offset:0
  v_mfma_f32_16x16x32_bf16 v[56:59], v[184:187], v[120:123], v[56:59]
  v_mfma_f32_16x16x32_bf16 v[60:63], v[184:187], v[124:127], v[60:63]
  buffer_load_dwordx4 v[200:203], v4, s[36:39], s33 offen offset:1024
  v_mfma_f32_16x16x32_bf16 v[64:67], v[188:191], v[112:115], v[64:67]
  v_mfma_f32_16x16x32_bf16 v[68:71], v[188:191], v[116:119], v[68:71]
  buffer_load_dwordx4 v[204:207], v4, s[36:39], s33 offen offset:2048
  v_mfma_f32_16x16x32_bf16 v[72:75], v[188:191], v[120:123], v[72:75]
  v_mfma_f32_16x16x32_bf16 v[76:79], v[188:191], v[124:127], v[76:79]
  buffer_load_dwordx4 v[208:211], v4, s[36:39], s33 offen offset:3072
  v_mfma_f32_16x16x32_bf16 v[80:83], v[192:195], v[112:115], v[80:83]
  v_mfma_f32_16x16x32_bf16 v[84:87], v[192:195], v[116:119], v[84:87]
  buffer_load_dwordx4 v[212:215], v5, s[36:39], s33 offen
  s_add_u32 s33, s33, 40960
  s_cmp_ge_u32 s33, 286720
  s_cselect_b32 s19, 286720, 0
  s_sub_u32 s33, s33, s19
  v_mfma_f32_16x16x32_bf16 v[88:91], v[192:195], v[120:123], v[88:91]
  v_mfma_f32_16x16x32_bf16 v[92:95], v[192:195], v[124:127], v[92:95]
  s_waitcnt vmcnt(18)
  ds_read_b128 v[176:179], v15 offset:16384
  ds_read_b128 v[180:183], v15 offset:17408
  ds_read_b128 v[184:187], v15 offset:18432
  ds_read_b128 v[188:191], v15 offset:19456
  ds_read_b128 v[192:195], v0 offset:1024
  s_waitcnt vmcnt(9)
  v_cmp_eq_u32 vcc, s15, v1
  s_nop 0
  s_or_b32 s66, s66, vcc_lo
  s_bitcmp1_b32 s66, 6
  s_cbranch_scc1 Lhr_9
  s_mov_b32 s67, 6
  s_call_b64 s[68:69], L_g2spin
Lhr_9:
  v_mfma_f32_16x16x32_bf16 v[16:19], v[216:219], v[128:131], v[16:19]
  v_mfma_f32_16x16x32_bf16 v[20:23], v[216:219], v[132:135], v[20:23]
  buffer_load_dwordx4 v[112:115], v6, s[24:27], s32 offen
  v_mfma_f32_16x16x32_bf16 v[24:27], v[216:219], v[136:139], v[24:27]
  v_mfma_f32_16x16x32_bf16 v[28:31], v[216:219], v[140:143], v[28:31]
  buffer_load_dwordx4 v[116:119], v7, s[24:27], s32 offen
  v_mfma_f32_16x16x32_bf16 v[32:35], v[220:223], v[128:131], v[32:35]
  v_mfma_f32_16x16x32_bf16 v[36:39], v[220:223], v[132:135], v[36:39]
  buffer_load_dwordx4 v[120:123], v8, s[24:27], s32 offen
  v_mfma_f32_16x16x32_bf16 v[40:43], v[220:223], v[136:139], v[40:43]
  v_mfma_f32_16x16x32_bf16 v[44:47], v[220:223], v[140:143], v[44:47]
  buffer_load_dwordx4 v[124:127], v9, s[24:27], s32 offen
  s_add_u32 s32, s32, 16384
  s_cmp_ge_u32 s32, 229376
  s_cselect_b32 s19, 229376, 0
  s_sub_u32 s32, s32, s19
  v_mfma_f32_16x16x32_bf16 v[48:51], v[224:227], v[128:131], v[48:51]
  v_mfma_f32_16x16x32_bf16 v[52:55], v[224:227], v[132:135], v[52:55]
  s_add_u32 s34, s34, 40960
  s_cmp_ge_u32 s34, 286720
  s_cselect_b32 s19, 286720, 0
  s_sub_u32 s34, s34, s19
  s_add_u32 m0, s35, 0
  s_min_u32 s90, s34, 271360
  buffer_load_dwordx4 v4, s[36:39], s90 offen offset:0  lds
  v_mfma_f32_16x16x32_bf16 v[56:59], v[224:227], v[136:139], v[56:59]
  v_mfma_f32_16x16x32_bf16 v[60:63], v[224:227], v[140:143], v[60:63]
  buffer_load_dwordx4 v4, s[36:39], s90 offen offset:1024  lds
  v_mfma_f32_16x16x32_bf16 v[64:67], v[228:231], v[128:131], v[64:67]
  v_mfma_f32_16x16x32_bf16 v[68:71], v[228:231], v[132:135], v[68:71]
  buffer_load_dwordx4 v4, s[36:39], s90 offen offset:2048  lds
  v_mfma_f32_16x16x32_bf16 v[72:75], v[228:231], v[136:139], v[72:75]
  v_mfma_f32_16x16x32_bf16 v[76:79], v[228:231], v[140:143], v[76:79]
  buffer_load_dwordx4 v4, s[36:39], s90 offen offset:3072  lds
  v_mfma_f32_16x16x32_bf16 v[80:83], v[232:235], v[128:131], v[80:83]
  v_mfma_f32_16x16x32_bf16 v[84:87], v[232:235], v[132:135], v[84:87]
  s_add_u32 m0, s35, 65536
  s_nop 0
  buffer_load_dwordx4 v5, s[36:39], s90 offen  lds
  v_mfma_f32_16x16x32_bf16 v[88:91], v[232:235], v[136:139], v[88:91]
  v_mfma_f32_16x16x32_bf16 v[92:95], v[232:235], v[140:143], v[92:95]
  buffer_load_dword v1, v3, s[8:11], s22 offen sc1
  s_waitcnt lgkmcnt(0)
  s_waitcnt vmcnt(24)
  s_bitcmp1_b32 s66, 7
  s_cbranch_scc1 Lhr_10
  s_mov_b32 s67, 7
  s_call_b64 s[68:69], L_g2spin
Lhr_10:
  v_mfma_f32_16x16x32_bf16 v[16:19], v[176:179], v[144:147], v[16:19]
  v_mfma_f32_16x16x32_bf16 v[20:23], v[176:179], v[148:151], v[20:23]
  buffer_load_dwordx4 v[128:131], v6, s[24:27], s32 offen
  v_mfma_f32_16x16x32_bf16 v[24:27], v[176:179], v[152:155], v[24:27]
  v_mfma_f32_16x16x32_bf16 v[28:31], v[176:179], v[156:159], v[28:31]
  buffer_load_dwordx4 v[132:135], v7, s[24:27], s32 offen
  v_mfma_f32_16x16x32_bf16 v[32:35], v[180:183], v[144:147], v[32:35]
  v_mfma_f32_16x16x32_bf16 v[36:39], v[180:183], v[148:151], v[36:39]
  buffer_load_dwordx4 v[136:139], v8, s[24:27], s32 offen
  v_mfma_f32_16x16x32_bf16 v[40:43], v[180:183], v[152:155], v[40:43]
  v_mfma_f32_16x16x32_bf16 v[44:47], v[180:183], v[156:159], v[44:47]
  buffer_load_dwordx4 v[140:143], v9, s[24:27], s32 offen
  s_add_u32 s32, s32, 16384
  s_cmp_ge_u32 s32, 229376
  s_cselect_b32 s19, 229376, 0
  s_sub_u32 s32, s32, s19
  v_mfma_f32_16x16x32_bf16 v[48:51], v[184:187], v[144:147], v[48:51]
  v_mfma_f32_16x16x32_bf16 v[52:55], v[184:187], v[148:151], v[52:55]
  buffer_load_dwordx4 v[216:219], v4, s[36:39], s33 offen offset:0
  v_mfma_f32_16x16x32_bf16 v[56:59], v[184:187], v[152:155], v[56:59]
  v_mfma_f32_16x16x32_bf16 v[60:63], v[184:187], v[156:159], v[60:63]
  buffer_load_dwordx4 v[220:223], v4, s[36:39], s33 offen offset:1024
  v_mfma_f32_16x16x32_bf16 v[64:67], v[188:191], v[144:147], v[64:67]
  v_mfma_f32_16x16x32_bf16 v[68:71], v[188:191], v[148:151], v[68:71]
  buffer_load_dwordx4 v[224:227], v4, s[36:39], s33 offen offset:2048
  v_mfma_f32_16x16x32_bf16 v[72:75], v[188:191], v[152:155], v[72:75]
  v_mfma_f32_16x16x32_bf16 v[76:79], v[188:191], v[156:159], v[76:79]
  buffer_load_dwordx4 v[228:231], v4, s[36:39], s33 offen offset:3072
  v_mfma_f32_16x16x32_bf16 v[80:83], v[192:195], v[144:147], v[80:83]
  v_mfma_f32_16x16x32_bf16 v[84:87], v[192:195], v[148:151], v[84:87]
  buffer_load_dwordx4 v[232:235], v5, s[36:39], s33 offen
  s_add_u32 s33, s33, 40960
  s_cmp_ge_u32 s33, 286720
  s_cselect_b32 s19, 286720, 0
  s_sub_u32 s33, s33, s19
  v_mfma_f32_16x16x32_bf16 v[88:91], v[192:195], v[152:155], v[88:91]
  v_mfma_f32_16x16x32_bf16 v[92:95], v[192:195], v[156:159], v[92:95]
  s_waitcnt vmcnt(29)
  ds_read_b128 v[176:179], v15 offset:32768
  ds_read_b128 v[180:183], v15 offset:33792
  ds_read_b128 v[184:187], v15 offset:34816
  ds_read_b128 v[188:191], v15 offset:35840
  ds_read_b128 v[192:195], v0 offset:2048
  s_bitcmp1_b32 s66, 8
  s_cbranch_scc1 Lhr_11
  s_mov_b32 s67, 8
  s_call_b64 s[68:69], L_g2spin
Lhr_11:
  v_mfma_f32_16x16x32_bf16 v[16:19], v[236:239], v[160:163], v[16:19]
  v_mfma_f32_16x16x32_bf16 v[20:23], v[236:239], v[164:167], v[20:23]
  buffer_load_dwordx4 v[144:147], v6, s[24:27], s32 offen
  v_mfma_f32_16x16x32_bf16 v[24:27], v[236:239], v[168:171], v[24:27]
  v_mfma_f32_16x16x32_bf16 v[28:31], v[236:239], v[172:175], v[28:31]
  buffer_load_dwordx4 v[148:151], v7, s[24:27], s32 offen
  v_mfma_f32_16x16x32_bf16 v[32:35], v[240:243], v[160:163], v[32:35]
  v_mfma_f32_16x16x32_bf16 v[36:39], v[240:243], v[164:167], v[36:39]
  buffer_load_dwordx4 v[152:155], v8, s[24:27], s32 offen
  v_mfma_f32_16x16x32_bf16 v[40:43], v[240:243], v[168:171], v[40:43]
  v_mfma_f32_16x16x32_bf16 v[44:47], v[240:243], v[172:175], v[44:47]
  buffer_load_dwordx4 v[156:159], v9, s[24:27], s32 offen
  s_add_u32 s32, s32, 16384
  s_cmp_ge_u32 s32, 229376
  s_cselect_b32 s19, 229376, 0
  s_sub_u32 s32, s32, s19
  v_mfma_f32_16x16x32_bf16 v[48:51], v[244:247], v[160:163], v[48:51]
  v_mfma_f32_16x16x32_bf16 v[52:55], v[244:247], v[164:167], v[52:55]
  s_add_u32 s34, s34, 40960
  s_cmp_ge_u32 s34, 286720
  s_cselect_b32 s19, 286720, 0
  s_sub_u32 s34, s34, s19
  s_add_u32 m0, s35, 16384
  s_min_u32 s90, s34, 271360
  buffer_load_dwordx4 v4, s[36:39], s90 offen offset:0  lds
  v_mfma_f32_16x16x32_bf16 v[56:59], v[244:247], v[168:171], v[56:59]
  v_mfma_f32_16x16x32_bf16 v[60:63], v[244:247], v[172:175], v[60:63]
  buffer_load_dwordx4 v4, s[36:39], s90 offen offset:1024  lds
  v_mfma_f32_16x16x32_bf16 v[64:67], v[248:251], v[160:163], v[64:67]
  v_mfma_f32_16x16x32_bf16 v[68:71], v[248:251], v[164:167], v[68:71]
  buffer_load_dwordx4 v4, s[36:39], s90 offen offset:2048  lds
  v_mfma_f32_16x16x32_bf16 v[72:75], v[248:251], v[168:171], v[72:75]
  v_mfma_f32_16x16x32_bf16 v[76:79], v[248:251], v[172:175], v[76:79]
  buffer_load_dwordx4 v4, s[36:39], s90 offen offset:3072  lds
  v_mfma_f32_16x16x32_bf16 v[80:83], v[252:255], v[160:163], v[80:83]
  v_mfma_f32_16x16x32_bf16 v[84:87], v[252:255], v[164:167], v[84:87]
  s_add_u32 m0, s35, 66560
  s_nop 0
  buffer_load_dwordx4 v5, s[36:39], s90 offen  lds
  v_mfma_f32_16x16x32_bf16 v[88:91], v[252:255], v[168:171], v[88:91]
  v_mfma_f32_16x16x32_bf16 v[92:95], v[252:255], v[172:175], v[92:95]
  s_waitcnt lgkmcnt(0)
  s_waitcnt vmcnt(33)
  s_waitcnt vmcnt(18)
  v_cmp_eq_u32 vcc, s15, v1
  s_nop 0
  s_or_b32 s66, s66, vcc_lo
  s_bitcmp1_b32 s66, 9
  s_cbranch_scc1 Lhr_12
  s_mov_b32 s67, 9
  s_call_b64 s[68:69], L_g2spin
Lhr_12:
  v_mfma_f32_16x16x32_bf16 v[16:19], v[176:179], v[96:99], v[16:19]
  v_mfma_f32_16x16x32_bf16 v[20:23], v[176:179], v[100:103], v[20:23]
  buffer_load_dwordx4 v[160:163], v6, s[24:27], s32 offen
  v_mfma_f32_16x16x32_bf16 v[24:27], v[176:179], v[104:107], v[24:27]
  v_mfma_f32_16x16x32_bf16 v[28:31], v[176:179], v[108:111], v[28:31]
  buffer_load_dwordx4 v[164:167], v7, s[24:27], s32 offen
  v_mfma_f32_16x16x32_bf16 v[32:35], v[180:183], v[96:99], v[32:35]
  v_mfma_f32_16x16x32_bf16 v[36:39], v[180:183], v[100:103], v[36:39]
  buffer_load_dwordx4 v[168:171], v8, s[24:27], s32 offen
  v_mfma_f32_16x16x32_bf16 v[40:43], v[180:183], v[104:107], v[40:43]
  v_mfma_f32_16x16x32_bf16 v[44:47], v[180:183], v[108:111], v[44:47]
  buffer_load_dwordx4 v[172:175], v9, s[24:27], s32 offen
  s_add_u32 s32, s32, 16384
  s_cmp_ge_u32 s32, 229376
  s_cselect_b32 s19, 229376, 0
  s_sub_u32 s32, s32, s19
  v_mfma_f32_16x16x32_bf16 v[48:51], v[184:187], v[96:99], v[48:51]
  v_mfma_f32_16x16x32_bf16 v[52:55], v[184:187], v[100:103], v[52:55]
  buffer_load_dwordx4 v[236:239], v4, s[36:39], s33 offen offset:0
  v_mfma_f32_16x16x32_bf16 v[56:59], v[184:187], v[104:107], v[56:59]
  v_mfma_f32_16x16x32_bf16 v[60:63], v[184:187], v[108:111], v[60:63]
  buffer_load_dwordx4 v[240:243], v4, s[36:39], s33 offen offset:1024
  v_mfma_f32_16x16x32_bf16 v[64:67], v[188:191], v[96:99], v[64:67]
  v_mfma_f32_16x16x32_bf16 v[68:71], v[188:191], v[100:103], v[68:71]
  buffer_load_dwordx4 v[244:247], v4, s[36:39], s33 offen offset:2048
  v_mfma_f32_16x16x32_bf16 v[72:75], v[188:191], v[104:107], v[72:75]
  v_mfma_f32_16x16x32_bf16 v[76:79], v[188:191], v[108:111], v[76:79]
  buffer_load_dwordx4 v[248:251], v4, s[36:39], s33 offen offset:3072
  v_mfma_f32_16x16x32_bf16 v[80:83], v[192:195], v[96:99], v[80:83]
  v_mfma_f32_16x16x32_bf16 v[84:87], v[192:195], v[100:103], v[84:87]
  buffer_load_dwordx4 v[252:255], v5, s[36:39], s33 offen
  s_add_u32 s33, s33, 40960
  s_cmp_ge_u32 s33, 286720
  s_cselect_b32 s19, 286720, 0
  s_sub_u32 s33, s33, s19
  v_mfma_f32_16x16x32_bf16 v[88:91], v[192:195], v[104:107], v[88:91]
  v_mfma_f32_16x16x32_bf16 v[92:95], v[192:195], v[108:111], v[92:95]
  s_waitcnt vmcnt(33)
  ds_read_b128 v[176:179], v15 offset:49152
  ds_read_b128 v[180:183], v15 offset:50176
  ds_read_b128 v[184:187], v15 offset:51200
  ds_read_b128 v[188:191], v15 offset:52224
  ds_read_b128 v[192:195], v0 offset:3072
  s_bitcmp1_b32 s66, 10
  s_cbranch_scc1 Lhr_13
  s_mov_b32 s67, 10
  s_call_b64 s[68:69], L_g2spin
Lhr_13:
  v_mfma_f32_16x16x32_bf16 v[16:19], v[196:199], v[112:115], v[16:19]
  v_mfma_f32_16x16x32_bf16 v[20:23], v[196:199], v[116:119], v[20:23]
  buffer_load_dwordx4 v[96:99], v6, s[24:27], s32 offen
  v_mfma_f32_16x16x32_bf16 v[24:27], v[196:199], v[120:123], v[24:27]
  v_mfma_f32_16x16x32_bf16 v[28:31], v[196:199], v[124:127], v[28:31]
  buffer_load_dwordx4 v[100:103], v7, s[24:27], s32 offen
  v_mfma_f32_16x16x32_bf16 v[32:35], v[200:203], v[112:115], v[32:35]
  v_mfma_f32_16x16x32_bf16 v[36:39], v[200:203], v[116:119], v[36:39]
  buffer_load_dwordx4 v[104:107], v8, s[24:27], s32 offen
  v_mfma_f32_16x16x32_bf16 v[40:43], v[200:203], v[120:123], v[40:43]
  v_mfma_f32_16x16x32_bf16 v[44:47], v[200:203], v[124:127], v[44:47]
  buffer_load_dwordx4 v[108:111], v9, s[24:27], s32 offen
  s_add_u32 s32, s32, 16384
  s_cmp_ge_u32 s32, 229376
  s_cselect_b32 s19, 229376, 0
  s_sub_u32 s32, s32, s19
  v_mfma_f32_16x16x32_bf16 v[48:51], v[204:207], v[112:115], v[48:51]
  v_mfma_f32_16x16x32_bf16 v[52:55], v[204:207], v[116:119], v[52:55]
  s_add_u32 s34, s34, 40960
  s_cmp_ge_u32 s34, 286720
  s_cselect_b32 s19, 286720, 0
  s_sub_u32 s34, s34, s19
  s_add_u32 m0, s35, 32768
  s_min_u32 s90, s34, 271360
  buffer_load_dwordx4 v4, s[36:39], s90 offen offset:0  lds
  v_mfma_f32_16x16x32_bf16 v[56:59], v[204:207], v[120:123], v[56:59]
  v_mfma_f32_16x16x32_bf16 v[60:63], v[204:207], v[124:127], v[60:63]
  buffer_load_dwordx4 v4, s[36:39], s90 offen offset:1024  lds
  v_mfma_f32_16x16x32_bf16 v[64:67], v[208:211], v[112:115], v[64:67]
  v_mfma_f32_16x16x32_bf16 v[68:71], v[208:211], v[116:119], v[68:71]
  buffer_load_dwordx4 v4, s[36:39], s90 offen offset:2048  lds
  v_mfma_f32_16x16x32_bf16 v[72:75], v[208:211], v[120:123], v[72:75]
  v_mfma_f32_16x16x32_bf16 v[76:79], v[208:211], v[124:127], v[76:79]
  buffer_load_dwordx4 v4, s[36:39], s90 offen offset:3072  lds
  v_mfma_f32_16x16x32_bf16 v[80:83], v[212:215], v[112:115], v[80:83]
  v_mfma_f32_16x16x32_bf16 v[84:87], v[212:215], v[116:119], v[84:87]
  s_add_u32 m0, s35, 67584
  s_nop 0
  buffer_load_dwordx4 v5, s[36:39], s90 offen  lds
  v_mfma_f32_16x16x32_bf16 v[88:91], v[212:215], v[120:123], v[88:91]
  v_mfma_f32_16x16x32_bf16 v[92:95], v[212:215], v[124:127], v[92:95]
  s_waitcnt lgkmcnt(0)
  s_waitcnt vmcnt(32)
  s_bitcmp1_b32 s66, 11
  s_cbranch_scc1 Lhr_14
  s_mov_b32 s67, 11
  s_call_b64 s[68:69], L_g2spin
Lhr_14:
  v_mfma_f32_16x16x32_bf16 v[16:19], v[176:179], v[128:131], v[16:19]
  v_mfma_f32_16x16x32_bf16 v[20:23], v[176:179], v[132:135], v[20:23]
  buffer_load_dwordx4 v[112:115], v6, s[24:27], s32 offen
  v_mfma_f32_16x16x32_bf16 v[24:27], v[176:179], v[136:139], v[24:27]
  v_mfma_f32_16x16x32_bf16 v[28:31], v[176:179], v[140:143], v[28:31]
  buffer_load_dwordx4 v[116:119], v7, s[24:27], s32 offen
  v_mfma_f32_16x16x32_bf16 v[32:35], v[180:183], v[128:131], v[32:35]
  v_mfma_f32_16x16x32_bf16 v[36:39], v[180:183], v[132:135], v[36:39]
  buffer_load_dwordx4 v[120:123], v8, s[24:27], s32 offen
  v_mfma_f32_16x16x32_bf16 v[40:43], v[180:183], v[136:139], v[40:43]
  v_mfma_f32_16x16x32_bf16 v[44:47], v[180:183], v[140:143], v[44:47]
  buffer_load_dwordx4 v[124:127], v9, s[24:27], s32 offen
  s_add_u32 s32, s32, 16384
  s_cmp_ge_u32 s32, 229376
  s_cselect_b32 s19, 229376, 0
  s_sub_u32 s32, s32, s19
  v_mfma_f32_16x16x32_bf16 v[48:51], v[184:187], v[128:131], v[48:51]
  v_mfma_f32_16x16x32_bf16 v[52:55], v[184:187], v[132:135], v[52:55]
  buffer_load_dwordx4 v[196:199], v4, s[36:39], s33 offen offset:0
  v_mfma_f32_16x16x32_bf16 v[56:59], v[184:187], v[136:139], v[56:59]
  v_mfma_f32_16x16x32_bf16 v[60:63], v[184:187], v[140:143], v[60:63]
  buffer_load_dwordx4 v[200:203], v4, s[36:39], s33 offen offset:1024
  v_mfma_f32_16x16x32_bf16 v[64:67], v[188:191], v[128:131], v[64:67]
  v_mfma_f32_16x16x32_bf16 v[68:71], v[188:191], v[132:135], v[68:71]
  buffer_load_dwordx4 v[204:207], v4, s[36:39], s33 offen offset:2048
  v_mfma_f32_16x16x32_bf16 v[72:75], v[188:191], v[136:139], v[72:75]
  v_mfma_f32_16x16x32_bf16 v[76:79], v[188:191], v[140:143], v[76:79]
  buffer_load_dwordx4 v[208:211], v4, s[36:39], s33 offen offset:3072
  v_mfma_f32_16x16x32_bf16 v[80:83], v[192:195], v[128:131], v[80:83]
  v_mfma_f32_16x16x32_bf16 v[84:87], v[192:195], v[132:135], v[84:87]
  buffer_load_dwordx4 v[212:215], v5, s[36:39], s33 offen
  v_mfma_f32_16x16x32_bf16 v[88:91], v[192:195], v[136:139], v[88:91]
  v_mfma_f32_16x16x32_bf16 v[92:95], v[192:195], v[140:143], v[92:95]
  s_waitcnt vmcnt(32)
  s_waitcnt vmcnt(46)
  ds_read_b128 v[176:179], v15 offset:0
  ds_read_b128 v[180:183], v15 offset:1024
  ds_read_b128 v[184:187], v15 offset:2048
  ds_read_b128 v[188:191], v15 offset:3072
  ds_read_b128 v[192:195], v0 offset:0
  s_bitcmp1_b32 s66, 12
  s_cbranch_scc1 Lhr_15
  s_mov_b32 s67, 12
  s_call_b64 s[68:69], L_g2spin
Lhr_15:
  v_mfma_f32_16x16x32_bf16 v[16:19], v[216:219], v[144:147], v[16:19]
  v_mfma_f32_16x16x32_bf16 v[20:23], v[216:219], v[148:151], v[20:23]
  buffer_load_dwordx4 v[128:131], v6, s[24:27], s32 offen
  v_mfma_f32_16x16x32_bf16 v[24:27], v[216:219], v[152:155], v[24:27]
  v_mfma_f32_16x16x32_bf16 v[28:31], v[216:219], v[156:159], v[28:31]
  buffer_load_dwordx4 v[132:135], v7, s[24:27], s32 offen
  v_mfma_f32_16x16x32_bf16 v[32:35], v[220:223], v[144:147], v[32:35]
  v_mfma_f32_16x16x32_bf16 v[36:39], v[220:223], v[148:151], v[36:39]
  buffer_load_dwordx4 v[136:139], v8, s[24:27], s32 offen
  v_mfma_f32_16x16x32_bf16 v[40:43], v[220:223], v[152:155], v[40:43]
  v_mfma_f32_16x16x32_bf16 v[44:47], v[220:223], v[156:159], v[44:47]
  buffer_load_dwordx4 v[140:143], v9, s[24:27], s32 offen
  s_add_u32 s32, s32, 16384
  s_cmp_ge_u32 s32, 229376
  s_cselect_b32 s19, 229376, 0
  s_sub_u32 s32, s32, s19
  v_mfma_f32_16x16x32_bf16 v[48:51], v[224:227], v[144:147], v[48:51]
  v_mfma_f32_16x16x32_bf16 v[52:55], v[224:227], v[148:151], v[52:55]
  v_mfma_f32_16x16x32_bf16 v[56:59], v[224:227], v[152:155], v[56:59]
  v_mfma_f32_16x16x32_bf16 v[60:63], v[224:227], v[156:159], v[60:63]
  v_mfma_f32_16x16x32_bf16 v[64:67], v[228:231], v[144:147], v[64:67]
  v_mfma_f32_16x16x32_bf16 v[68:71], v[228:231], v[148:151], v[68:71]
  v_mfma_f32_16x16x32_bf16 v[72:75], v[228:231], v[152:155], v[72:75]
  v_mfma_f32_16x16x32_bf16 v[76:79], v[228:231], v[156:159], v[76:79]
  v_mfma_f32_16x16x32_bf16 v[80:83], v[232:235], v[144:147], v[80:83]
  v_mfma_f32_16x16x32_bf16 v[84:87], v[232:235], v[148:151], v[84:87]
  v_mfma_f32_16x16x32_bf16 v[88:91], v[232:235], v[152:155], v[88:91]
  v_mfma_f32_16x16x32_bf16 v[92:95], v[232:235], v[156:159], v[92:95]
  s_waitcnt lgkmcnt(0)
  s_waitcnt vmcnt(27)
  s_bitcmp1_b32 s66, 13
  s_cbranch_scc1 Lhr_16
  s_mov_b32 s67, 13
  s_call_b64 s[68:69], L_g2spin
Lhr_16:
  v_mfma_f32_16x16x32_bf16 v[16:19], v[176:179], v[160:163], v[16:19]
  v_mfma_f32_16x16x32_bf16 v[20:23], v[176:179], v[164:167], v[20:23]
  buffer_load_dwordx4 v[144:147], v6, s[24:27], s32 offen
  v_mfma_f32_16x16x32_bf16 v[24:27], v[176:179], v[168:171], v[24:27]
  v_mfma_f32_16x16x32_bf16 v[28:31], v[176:179], v[172:175], v[28:31]
  buffer_load_dwordx4 v[148:151], v7, s[24:27], s32 offen
  v_mfma_f32_16x16x32_bf16 v[32:35], v[180:183], v[160:163], v[32:35]
  v_mfma_f32_16x16x32_bf16 v[36:39], v[180:183], v[164:167], v[36:39]
  buffer_load_dwordx4 v[152:155], v8, s[24:27], s32 offen
  v_mfma_f32_16x16x32_bf16 v[40:43], v[180:183], v[168:171], v[40:43]
  v_mfma_f32_16x16x32_bf16 v[44:47], v[180:183], v[172:175], v[44:47]
  buffer_load_dwordx4 v[156:159], v9, s[24:27], s32 offen
  v_mfma_f32_16x16x32_bf16 v[48:51], v[184:187], v[160:163], v[48:51]
  v_mfma_f32_16x16x32_bf16 v[52:55], v[184:187], v[164:167], v[52:55]
  v_mfma_f32_16x16x32_bf16 v[56:59], v[184:187], v[168:171], v[56:59]
  v_mfma_f32_16x16x32_bf16 v[60:63], v[184:187], v[172:175], v[60:63]
  v_mfma_f32_16x16x32_bf16 v[64:67], v[188:191], v[160:163], v[64:67]
  v_mfma_f32_16x16x32_bf16 v[68:71], v[188:191], v[164:167], v[68:71]
  v_mfma_f32_16x16x32_bf16 v[72:75], v[188:191], v[168:171], v[72:75]
  v_mfma_f32_16x16x32_bf16 v[76:79], v[188:191], v[172:175], v[76:79]
  v_mfma_f32_16x16x32_bf16 v[80:83], v[192:195], v[160:163], v[80:83]
  v_mfma_f32_16x16x32_bf16 v[84:87], v[192:195], v[164:167], v[84:87]
  v_mfma_f32_16x16x32_bf16 v[88:91], v[192:195], v[168:171], v[88:91]
  v_mfma_f32_16x16x32_bf16 v[92:95], v[192:195], v[172:175], v[92:95]
  buffer_load_dwordx2 v[216:217], v13, s[28:31], 0 offen offset:0
  buffer_load_dwordx2 v[218:219], v13, s[28:31], 0 offen offset:32
  buffer_load_dwordx2 v[220:221], v13, s[28:31], 0 offen offset:64
  buffer_load_dwordx2 v[222:223], v13, s[28:31], 0 offen offset:96
  buffer_load_dwordx2 v[224:225], v13, s[28:31], 0 offen offset:128
  buffer_load_dwordx2 v[226:227], v12, s[44:47], 0 offen offset:0
  buffer_load_dwordx2 v[228:229], v12, s[44:47], 0 offen offset:32
  buffer_load_dwordx2 v[230:231], v12, s[44:47], 0 offen offset:64
  buffer_load_dwordx2 v[232:233], v12, s[44:47], 0 offen offset:96
  buffer_load_dwordx2 v[234:235], v12, s[44:47], 0 offen offset:128
  s_waitcnt vmcnt(32)
  s_waitcnt vmcnt(45)
  ds_read_b128 v[176:179], v15 offset:16384
  ds_read_b128 v[180:183], v15 offset:17408
  ds_read_b128 v[184:187], v15 offset:18432
  ds_read_b128 v[188:191], v15 offset:19456
  ds_read_b128 v[192:195], v0 offset:1024
  v_mfma_f32_16x16x32_bf16 v[16:19], v[236:239], v[96:99], v[16:19]
  v_mfma_f32_16x16x32_bf16 v[20:23], v[236:239], v[100:103], v[20:23]
  v_mfma_f32_16x16x32_bf16 v[24:27], v[236:239], v[104:107], v[24:27]
  v_mfma_f32_16x16x32_bf16 v[28:31], v[236:239], v[108:111], v[28:31]
  v_mfma_f32_16x16x32_bf16 v[32:35], v[240:243], v[96:99], v[32:35]
  v_mfma_f32_16x16x32_bf16 v[36:39], v[240:243], v[100:103], v[36:39]
  v_mfma_f32_16x16x32_bf16 v[40:43], v[240:243], v[104:107], v[40:43]
  v_mfma_f32_16x16x32_bf16 v[44:47], v[240:243], v[108:111], v[44:47]
  v_mfma_f32_16x16x32_bf16 v[48:51], v[244:247], v[96:99], v[48:51]
  v_mfma_f32_16x16x32_bf16 v[52:55], v[244:247], v[100:103], v[52:55]
  v_mfma_f32_16x16x32_bf16 v[56:59], v[244:247], v[104:107], v[56:59]
  v_mfma_f32_16x16x32_bf16 v[60:63], v[244:247], v[108:111], v[60:63]
  v_mfma_f32_16x16x32_bf16 v[64:67], v[248:251], v[96:99], v[64:67]
  v_mfma_f32_16x16x32_bf16 v[68:71], v[248:251], v[100:103], v[68:71]
  v_mfma_f32_16x16x32_bf16 v[72:75], v[248:251], v[104:107], v[72:75]
  v_mfma_f32_16x16x32_bf16 v[76:79], v[248:251], v[108:111], v[76:79]
  v_mfma_f32_16x16x32_bf16 v[80:83], v[252:255], v[96:99], v[80:83]
  v_mfma_f32_16x16x32_bf16 v[84:87], v[252:255], v[100:103], v[84:87]
  v_mfma_f32_16x16x32_bf16 v[88:91], v[252:255], v[104:107], v[88:91]
  v_mfma_f32_16x16x32_bf16 v[92:95], v[252:255], v[108:111], v[92:95]
  buffer_load_dword v10, v11, s[8:11], s58 offen sc1
  s_waitcnt lgkmcnt(0)
  s_waitcnt vmcnt(24)
  v_mfma_f32_16x16x32_bf16 v[16:19], v[176:179], v[112:115], v[16:19]
  v_mfma_f32_16x16x32_bf16 v[20:23], v[176:179], v[116:119], v[20:23]
  v_mfma_f32_16x16x32_bf16 v[24:27], v[176:179], v[120:123], v[24:27]
  v_mfma_f32_16x16x32_bf16 v[28:31], v[176:179], v[124:127], v[28:31]
  v_mfma_f32_16x16x32_bf16 v[32:35], v[180:183], v[112:115], v[32:35]
  v_mfma_f32_16x16x32_bf16 v[36:39], v[180:183], v[116:119], v[36:39]
  v_mfma_f32_16x16x32_bf16 v[40:43], v[180:183], v[120:123], v[40:43]
  v_mfma_f32_16x16x32_bf16 v[44:47], v[180:183], v[124:127], v[44:47]
  v_mfma_f32_16x16x32_bf16 v[48:51], v[184:187], v[112:115], v[48:51]
  v_mfma_f32_16x16x32_bf16 v[52:55], v[184:187], v[116:119], v[52:55]
  v_mfma_f32_16x16x32_bf16 v[56:59], v[184:187], v[120:123], v[56:59]
  v_mfma_f32_16x16x32_bf16 v[60:63], v[184:187], v[124:127], v[60:63]
  v_mfma_f32_16x16x32_bf16 v[64:67], v[188:191], v[112:115], v[64:67]
  v_mfma_f32_16x16x32_bf16 v[68:71], v[188:191], v[116:119], v[68:71]
  v_mfma_f32_16x16x32_bf16 v[72:75], v[188:191], v[120:123], v[72:75]
  v_mfma_f32_16x16x32_bf16 v[76:79], v[188:191], v[124:127], v[76:79]
  v_mfma_f32_16x16x32_bf16 v[80:83], v[192:195], v[112:115], v[80:83]
  v_mfma_f32_16x16x32_bf16 v[84:87], v[192:195], v[116:119], v[84:87]
  v_mfma_f32_16x16x32_bf16 v[88:91], v[192:195], v[120:123], v[88:91]
  v_mfma_f32_16x16x32_bf16 v[92:95], v[192:195], v[124:127], v[92:95]
  s_waitcnt vmcnt(15)
  s_waitcnt vmcnt(28)
  ds_read_b128 v[176:179], v15 offset:32768
  ds_read_b128 v[180:183], v15 offset:33792
  ds_read_b128 v[184:187], v15 offset:34816
  ds_read_b128 v[188:191], v15 offset:35840
  ds_read_b128 v[192:195], v0 offset:2048
  v_mfma_f32_16x16x32_bf16 v[16:19], v[196:199], v[128:131], v[16:19]
  v_mfma_f32_16x16x32_bf16 v[20:23], v[196:199], v[132:135], v[20:23]
  v_mfma_f32_16x16x32_bf16 v[24:27], v[196:199], v[136:139], v[24:27]
  v_mfma_f32_16x16x32_bf16 v[28:31], v[196:199], v[140:143], v[28:31]
  v_mfma_f32_16x16x32_bf16 v[32:35], v[200:203], v[128:131], v[32:35]
  v_mfma_f32_16x16x32_bf16 v[36:39], v[200:203], v[132:135], v[36:39]
  v_mfma_f32_16x16x32_bf16 v[40:43], v[200:203], v[136:139], v[40:43]
  v_mfma_f32_16x16x32_bf16 v[44:47], v[200:203], v[140:143], v[44:47]
  v_mfma_f32_16x16x32_bf16 v[48:51], v[204:207], v[128:131], v[48:51]
  v_mfma_f32_16x16x32_bf16 v[52:55], v[204:207], v[132:135], v[52:55]
  v_mfma_f32_16x16x32_bf16 v[56:59], v[204:207], v[136:139], v[56:59]
  v_mfma_f32_16x16x32_bf16 v[60:63], v[204:207], v[140:143], v[60:63]
  v_mfma_f32_16x16x32_bf16 v[64:67], v[208:211], v[128:131], v[64:67]
  v_mfma_f32_16x16x32_bf16 v[68:71], v[208:211], v[132:135], v[68:71]
  v_mfma_f32_16x16x32_bf16 v[72:75], v[208:211], v[136:139], v[72:75]
  v_mfma_f32_16x16x32_bf16 v[76:79], v[208:211], v[140:143], v[76:79]
  v_mfma_f32_16x16x32_bf16 v[80:83], v[212:215], v[128:131], v[80:83]
  v_mfma_f32_16x16x32_bf16 v[84:87], v[212:215], v[132:135], v[84:87]
  v_mfma_f32_16x16x32_bf16 v[88:91], v[212:215], v[136:139], v[88:91]
  v_mfma_f32_16x16x32_bf16 v[92:95], v[212:215], v[140:143], v[92:95]
  s_waitcnt lgkmcnt(0)
  s_waitcnt vmcnt(11)
  v_mfma_f32_16x16x32_bf16 v[16:19], v[176:179], v[144:147], v[16:19]
  v_mfma_f32_16x16x32_bf16 v[20:23], v[176:179], v[148:151], v[20:23]
  v_mfma_f32_16x16x32_bf16 v[24:27], v[176:179], v[152:155], v[24:27]
  v_mfma_f32_16x16x32_bf16 v[28:31], v[176:179], v[156:159], v[28:31]
  v_mfma_f32_16x16x32_bf16 v[32:35], v[180:183], v[144:147], v[32:35]
  v_mfma_f32_16x16x32_bf16 v[36:39], v[180:183], v[148:151], v[36:39]
  v_mfma_f32_16x16x32_bf16 v[40:43], v[180:183], v[152:155], v[40:43]
  v_mfma_f32_16x16x32_bf16 v[44:47], v[180:183], v[156:159], v[44:47]
  v_mfma_f32_16x16x32_bf16 v[48:51], v[184:187], v[144:147], v[48:51]
  v_mfma_f32_16x16x32_bf16 v[52:55], v[184:187], v[148:151], v[52:55]
  v_mfma_f32_16x16x32_bf16 v[56:59], v[184:187], v[152:155], v[56:59]
  v_mfma_f32_16x16x32_bf16 v[60:63], v[184:187], v[156:159], v[60:63]
  v_mfma_f32_16x16x32_bf16 v[64:67], v[188:191], v[144:147], v[64:67]
  v_mfma_f32_16x16x32_bf16 v[68:71], v[188:191], v[148:151], v[68:71]
  v_mfma_f32_16x16x32_bf16 v[72:75], v[188:191], v[152:155], v[72:75]
  v_mfma_f32_16x16x32_bf16 v[76:79], v[188:191], v[156:159], v[76:79]
  v_mfma_f32_16x16x32_bf16 v[80:83], v[192:195], v[144:147], v[80:83]
  v_mfma_f32_16x16x32_bf16 v[84:87], v[192:195], v[148:151], v[84:87]
  v_mfma_f32_16x16x32_bf16 v[88:91], v[192:195], v[152:155], v[88:91]
  v_mfma_f32_16x16x32_bf16 v[92:95], v[192:195], v[156:159], v[92:95]
  s_waitcnt vmcnt(0)
  s_bitcmp1_b32 s3, 11
  s_cbranch_scc0 Lpd_18
  s_mov_b32 s91, 0
Lpl_17:
  v_cmp_ne_u32 vcc, s15, v10
  s_add_u32 s91, s91, 1
  s_cmp_eq_u64 vcc, 0
  s_cbranch_scc1 Lpd_18
  s_sleep 4
  buffer_load_dword v10, v11, s[8:11], s58 offen sc1
  s_waitcnt vmcnt(0)
  s_cmp_lt_u32 s91, 65536
  s_cbranch_scc1 Lpl_17
Lpd_18:
  s_add_u32 m0, s56, 0
  s_nop 0
  buffer_load_dwordx4 v14, s[48:51], s57 offen  lds
  s_add_u32 s57, s57, 131072
  s_add_u32 m0, s56, 1024
  s_nop 0
  buffer_load_dwordx4 v14, s[48:51], s57 offen  lds
  s_add_u32 s57, s57, 131072
  s_add_u32 m0, s56, 2048
  s_mov_b32 exec_hi, 0
  buffer_load_dwordx4 v14, s[48:51], s57 offen  lds
  s_mov_b32 exec_hi, -1
  s_xor_b32 s23, s12, 1
  s_lshl_b32 s23, s23, 12
  v_add_u32 v6, s23, v4
  v_add_u32 v97, 65536, v6
  s_xor_b32 s23, s12, 2
  s_lshl_b32 s23, s23, 12
  v_add_u32 v7, s23, v4
  v_add_u32 v98, 65536, v7
  s_xor_b32 s23, s12, 3
  s_lshl_b32 s23, s23, 12
  v_add_u32 v8, s23, v4
  v_add_u32 v99, 65536, v8
  v_lshl_add_u32 v9, v2, 3, s56
  s_barrier
  ds_write_b128 v6, v[20:23] offset:0
  ds_write_b128 v6, v[36:39] offset:1024
  ds_write_b128 v6, v[52:55] offset:2048
  ds_write_b128 v6, v[68:71] offset:3072
  ds_write_b128 v97, v[84:87] offset:0
  ds_write_b128 v7, v[24:27] offset:16384
  ds_write_b128 v7, v[40:43] offset:17408
  ds_write_b128 v7, v[56:59] offset:18432
  ds_write_b128 v7, v[72:75] offset:19456
  ds_write_b128 v98, v[88:91] offset:1024
  ds_write_b128 v8, v[28:31] offset:32768
  ds_write_b128 v8, v[44:47] offset:33792
  ds_write_b128 v8, v[60:63] offset:34816
  ds_write_b128 v8, v[76:79] offset:35840
  ds_write_b128 v99, v[92:95] offset:2048
  s_waitcnt lgkmcnt(0)
  s_barrier
  ds_read_b128 v[96:99], v15 offset:0
  ds_read_b128 v[100:103], v15 offset:1024
  ds_read_b128 v[104:107], v15 offset:2048
  ds_read_b128 v[108:111], v15 offset:3072
  ds_read_b128 v[112:115], v0 offset:0
  ds_read_b128 v[116:119], v15 offset:16384
  ds_read_b128 v[120:123], v15 offset:17408
  ds_read_b128 v[124:127], v15 offset:18432
  ds_read_b128 v[128:131], v15 offset:19456
  ds_read_b128 v[132:135], v0 offset:1024
  ds_read_b128 v[136:139], v15 offset:32768
  ds_read_b128 v[140:143], v15 offset:33792
  ds_read_b128 v[144:147], v15 offset:34816
  ds_read_b128 v[148:151], v15 offset:35840
  ds_read_b128 v[152:155], v0 offset:2048
  s_waitcnt vmcnt(3)
  s_mov_b32 s58, 0xbfb8aa3b
  s_mov_b32 s59, 0xbfb8aa3b
  s_mov_b32 s60, 0xffff0000
  v_lshlrev_b32 v160, 16, v226
  v_and_b32 v161, s60, v226
  v_pk_add_f32 v[16:17], v[16:17], v[160:161]
  v_lshlrev_b32 v160, 16, v227
  v_and_b32 v161, s60, v227
  v_pk_add_f32 v[18:19], v[18:19], v[160:161]
  v_lshlrev_b32 v160, 16, v228
  v_and_b32 v161, s60, v228
  v_pk_add_f32 v[32:33], v[32:33], v[160:161]
  v_lshlrev_b32 v160, 16, v229
  v_and_b32 v161, s60, v229
  v_pk_add_f32 v[34:35], v[34:35], v[160:161]
  v_lshlrev_b32 v160, 16, v230
  v_and_b32 v161, s60, v230
  v_pk_add_f32 v[48:49], v[48:49], v[160:161]
  v_lshlrev_b32 v160, 16, v231
  v_and_b32 v161, s60, v231
  v_pk_add_f32 v[50:51], v[50:51], v[160:161]
  v_lshlrev_b32 v160, 16, v232
  v_and_b32 v161, s60, v232
  v_pk_add_f32 v[64:65], v[64:65], v[160:161]
  v_lshlrev_b32 v160, 16, v233
  v_and_b32 v161, s60, v233
  v_pk_add_f32 v[66:67], v[66:67], v[160:161]
  v_lshlrev_b32 v160, 16, v234
  v_and_b32 v161, s60, v234
  v_pk_add_f32 v[80:81], v[80:81], v[160:161]
  v_lshlrev_b32 v160, 16, v235
  v_and_b32 v161, s60, v235
  v_pk_add_f32 v[82:83], v[82:83], v[160:161]
  s_waitcnt lgkmcnt(10)
  v_pk_add_f32 v[16:17], v[16:17], v[96:97]
  v_pk_add_f32 v[18:19], v[18:19], v[98:99]
  v_pk_add_f32 v[32:33], v[32:33], v[100:101]
  v_pk_add_f32 v[34:35], v[34:35], v[102:103]
  v_pk_add_f32 v[48:49], v[48:49], v[104:105]
  v_pk_add_f32 v[50:51], v[50:51], v[106:107]
  v_pk_add_f32 v[64:65], v[64:65], v[108:109]
  v_pk_add_f32 v[66:67], v[66:67], v[110:111]
  v_pk_add_f32 v[80:81], v[80:81], v[112:113]
  v_pk_add_f32 v[82:83], v[82:83], v[114:115]
  s_waitcnt lgkmcnt(5)
  v_pk_add_f32 v[16:17], v[16:17], v[116:117]
  v_pk_add_f32 v[18:19], v[18:19], v[118:119]
  v_pk_add_f32 v[32:33], v[32:33], v[120:121]
  v_pk_add_f32 v[34:35], v[34:35], v[122:123]
  v_pk_add_f32 v[48:49], v[48:49], v[124:125]
  v_pk_add_f32 v[50:51], v[50:51], v[126:127]
  v_pk_add_f32 v[64:65], v[64:65], v[128:129]
  v_pk_add_f32 v[66:67], v[66:67], v[130:131]
  v_pk_add_f32 v[80:81], v[80:81], v[132:133]
  v_pk_add_f32 v[82:83], v[82:83], v[134:135]
  s_waitcnt lgkmcnt(0)
  v_pk_add_f32 v[16:17], v[16:17], v[136:137]
  v_pk_add_f32 v[18:19], v[18:19], v[138:139]
  v_pk_add_f32 v[32:33], v[32:33], v[140:141]
  v_pk_add_f32 v[34:35], v[34:35], v[142:143]
  v_pk_add_f32 v[48:49], v[48:49], v[144:145]
  v_pk_add_f32 v[50:51], v[50:51], v[146:147]
  v_pk_add_f32 v[64:65], v[64:65], v[148:149]
  v_pk_add_f32 v[66:67], v[66:67], v[150:151]
  v_pk_add_f32 v[80:81], v[80:81], v[152:153]
  v_pk_add_f32 v[82:83], v[82:83], v[154:155]
  v_pk_mul_f32 v[96:97], v[16:17], s[58:59]
  v_pk_mul_f32 v[98:99], v[18:19], s[58:59]
  v_pk_mul_f32 v[100:101], v[32:33], s[58:59]
  v_pk_mul_f32 v[102:103], v[34:35], s[58:59]
  v_pk_mul_f32 v[104:105], v[48:49], s[58:59]
  v_pk_mul_f32 v[106:107], v[50:51], s[58:59]
  v_pk_mul_f32 v[108:109], v[64:65], s[58:59]
  v_pk_mul_f32 v[110:111], v[66:67], s[58:59]
  v_pk_mul_f32 v[112:113], v[80:81], s[58:59]
  v_pk_mul_f32 v[114:115], v[82:83], s[58:59]
  v_exp_f32 v96, v96
  v_exp_f32 v97, v97
  v_exp_f32 v98, v98
  v_exp_f32 v99, v99
  v_exp_f32 v100, v100
  v_exp_f32 v101, v101
  v_exp_f32 v102, v102
  v_exp_f32 v103, v103
  v_exp_f32 v104, v104
  v_exp_f32 v105, v105
  v_exp_f32 v106, v106
  v_exp_f32 v107, v107
  v_exp_f32 v108, v108
  v_exp_f32 v109, v109
  v_exp_f32 v110, v110
  v_exp_f32 v111, v111
  v_exp_f32 v112, v112
  v_exp_f32 v113, v113
  v_exp_f32 v114, v114
  v_exp_f32 v115, v115
  s_waitcnt vmcnt(0)
  ds_read_b64_tr_b16 v[240:241], v9 offset:0
  ds_read_b64_tr_b16 v[242:243], v9 offset:512
  ds_read_b64_tr_b16 v[244:245], v9 offset:1024
  ds_read_b64_tr_b16 v[246:247], v9 offset:1536
  ds_read_b64_tr_b16 v[248:249], v9 offset:2048
  v_pk_add_f32 v[96:97], v[96:97], 1.0 op_sel_hi:[1,0]
  v_pk_add_f32 v[98:99], v[98:99], 1.0 op_sel_hi:[1,0]
  v_pk_add_f32 v[100:101], v[100:101], 1.0 op_sel_hi:[1,0]
  v_pk_add_f32 v[102:103], v[102:103], 1.0 op_sel_hi:[1,0]
  v_pk_add_f32 v[104:105], v[104:105], 1.0 op_sel_hi:[1,0]
  v_pk_add_f32 v[106:107], v[106:107], 1.0 op_sel_hi:[1,0]
  v_pk_add_f32 v[108:109], v[108:109], 1.0 op_sel_hi:[1,0]
  v_pk_add_f32 v[110:111], v[110:111], 1.0 op_sel_hi:[1,0]
  v_pk_add_f32 v[112:113], v[112:113], 1.0 op_sel_hi:[1,0]
  v_pk_add_f32 v[114:115], v[114:115], 1.0 op_sel_hi:[1,0]
  v_rcp_f32 v96, v96
  v_rcp_f32 v97, v97
  v_rcp_f32 v98, v98
  v_rcp_f32 v99, v99
  v_rcp_f32 v100, v100
  v_rcp_f32 v101, v101
  v_rcp_f32 v102, v102
  v_rcp_f32 v103, v103
  v_rcp_f32 v104, v104
  v_rcp_f32 v105, v105
  v_rcp_f32 v106, v106
  v_rcp_f32 v107, v107
  v_rcp_f32 v108, v108
  v_rcp_f32 v109, v109
  v_rcp_f32 v110, v110
  v_rcp_f32 v111, v111
  v_rcp_f32 v112, v112
  v_rcp_f32 v113, v113
  v_rcp_f32 v114, v114
  v_rcp_f32 v115, v115
  v_pk_mul_f32 v[16:17], v[16:17], v[96:97]
  v_pk_mul_f32 v[18:19], v[18:19], v[98:99]
  v_pk_mul_f32 v[32:33], v[32:33], v[100:101]
  v_pk_mul_f32 v[34:35], v[34:35], v[102:103]
  v_pk_mul_f32 v[48:49], v[48:49], v[104:105]
  v_pk_mul_f32 v[50:51], v[50:51], v[106:107]
  v_pk_mul_f32 v[64:65], v[64:65], v[108:109]
  v_pk_mul_f32 v[66:67], v[66:67], v[110:111]
  v_pk_mul_f32 v[80:81], v[80:81], v[112:113]
  v_pk_mul_f32 v[82:83], v[82:83], v[114:115]
  s_waitcnt lgkmcnt(0)
  v_lshlrev_b32 v96, 16, v240
  v_and_b32 v97, s60, v240
  v_lshlrev_b32 v176, 16, v216
  v_and_b32 v177, s60, v216
  v_lshlrev_b32 v98, 16, v241
  v_and_b32 v99, s60, v241
  v_lshlrev_b32 v178, 16, v217
  v_and_b32 v179, s60, v217
  v_lshlrev_b32 v100, 16, v242
  v_and_b32 v101, s60, v242
  v_lshlrev_b32 v180, 16, v218
  v_and_b32 v181, s60, v218
  v_lshlrev_b32 v102, 16, v243
  v_and_b32 v103, s60, v243
  v_lshlrev_b32 v182, 16, v219
  v_and_b32 v183, s60, v219
  v_lshlrev_b32 v104, 16, v244
  v_and_b32 v105, s60, v244
  v_lshlrev_b32 v184, 16, v220
  v_and_b32 v185, s60, v220
  v_lshlrev_b32 v106, 16, v245
  v_and_b32 v107, s60, v245
  v_lshlrev_b32 v186, 16, v221
  v_and_b32 v187, s60, v221
  v_lshlrev_b32 v108, 16, v246
  v_and_b32 v109, s60, v246
  v_lshlrev_b32 v188, 16, v222
  v_and_b32 v189, s60, v222
  v_lshlrev_b32 v110, 16, v247
  v_and_b32 v111, s60, v247
  v_lshlrev_b32 v190, 16, v223
  v_and_b32 v191, s60, v223
  v_lshlrev_b32 v112, 16, v248
  v_and_b32 v113, s60, v248
  v_lshlrev_b32 v192, 16, v224
  v_and_b32 v193, s60, v224
  v_lshlrev_b32 v114, 16, v249
  v_and_b32 v115, s60, v249
  v_lshlrev_b32 v194, 16, v225
  v_and_b32 v195, s60, v225
  v_pk_fma_f32 v[16:17], v[16:17], v[96:97], v[176:177]
  v_pk_fma_f32 v[18:19], v[18:19], v[98:99], v[178:179]
  v_pk_fma_f32 v[32:33], v[32:33], v[100:101], v[180:181]
  v_pk_fma_f32 v[34:35], v[34:35], v[102:103], v[182:183]
  v_pk_fma_f32 v[48:49], v[48:49], v[104:105], v[184:185]
  v_pk_fma_f32 v[50:51], v[50:51], v[106:107], v[186:187]
  v_pk_fma_f32 v[64:65], v[64:65], v[108:109], v[188:189]
  v_pk_fma_f32 v[66:67], v[66:67], v[110:111], v[190:191]
  v_pk_fma_f32 v[80:81], v[80:81], v[112:113], v[192:193]
  v_pk_fma_f32 v[82:83], v[82:83], v[114:115], v[194:195]
  v_cvt_pk_bf16_f32 v120, v16, v17
  v_cvt_pk_bf16_f32 v121, v18, v19
  buffer_store_dwordx2 v[120:121], v13, s[40:43], 0 offen offset:0
  v_cvt_pk_bf16_f32 v122, v32, v33
  v_cvt_pk_bf16_f32 v123, v34, v35
  buffer_store_dwordx2 v[122:123], v13, s[40:43], 0 offen offset:32
  v_cvt_pk_bf16_f32 v124, v48, v49
  v_cvt_pk_bf16_f32 v125, v50, v51
  buffer_store_dwordx2 v[124:125], v13, s[40:43], 0 offen offset:64
  v_cvt_pk_bf16_f32 v126, v64, v65
  v_cvt_pk_bf16_f32 v127, v66, v67
  buffer_store_dwordx2 v[126:127], v13, s[40:43], 0 offen offset:96
  v_cvt_pk_bf16_f32 v128, v80, v81
  v_cvt_pk_bf16_f32 v129, v82, v83
  buffer_store_dwordx2 v[128:129], v13, s[40:43], 0 offen offset:128
  s_endpgm
L_g2spin:
  s_mov_b32 s91, 0
L_g2spl:
  buffer_load_dword v1, v3, s[8:11], s22 offen sc1
  s_waitcnt vmcnt(0)
  v_cmp_eq_u32 vcc, s15, v1
  s_nop 0
  s_or_b32 s66, s66, vcc_lo
  s_add_u32 s91, s91, 1
  s_bitcmp1_b32 s66, s67
  s_cbranch_scc1 L_g2spd
  s_sleep 2
  s_cmp_lt_u32 s91, 0x20000
  s_cbranch_scc1 L_g2spl
L_g2spd:
  s_setpc_b64 s[68:69]
R_LN:
  s_lshl_b32 s19, s23, 1
  s_sub_u32 s19, 28, s19
  s_cmp_lt_u32 s18, s19
  s_cselect_b32 s19, 0, 64
  s_mul_i32 s22, s23, 28
  s_add_u32 s18, s18, s22
  s_add_u32 s18, s18, s19
  s_lshl_b32 s22, s20, 2
  s_add_u32 s22, s22, s21
  s_lshl_b32 s23, s22, 5
  s_lshl_b32 s24, s12, 3
  s_add_u32 s23, s23, s24
  v_lshrrev_b32 v3, 4, v2
  v_and_b32 v4, 15, v2
  v_add_u32 v5, s23, v3
  v_mul_u32_u24 v6, 1280, v5
  v_lshl_add_u32 v6, v4, 4, v6
  v_add_u32 v7, 5120, v6
  v_lshrrev_b32 v15, 2, v2
  s_mul_i32 s24, s12, 160
  v_add_u32 v15, s24, v15
  v_mul_u32_u24 v15, 3456, v15
  v_and_b32 v9, 3, v2
  v_lshl_add_u32 v15, v9, 4, v15
  s_lshl_b32 s36, s18, 6
  s_cmp_lt_u32 s18, 54
  s_cselect_b32 s36, s36, 0x40000000
  s_waitcnt lgkmcnt(0)
  s_mov_b32 s24, s16
  s_mov_b32 s25, s17
  s_mov_b32 s26, 2621440
  s_mov_b32 s27, 0x00020000
  buffer_load_dwordx4 v[16:19], v6, s[24:27], 0 offen offset:0
  buffer_load_dwordx4 v[20:23], v6, s[24:27], 0 offen offset:256
  buffer_load_dwordx4 v[24:27], v6, s[24:27], 0 offen offset:512
  buffer_load_dwordx4 v[28:31], v6, s[24:27], 0 offen offset:768
  buffer_load_dwordx4 v[32:35], v6, s[24:27], 0 offen offset:1024
  buffer_load_dwordx4 v[36:39], v7, s[24:27], 0 offen offset:0
  buffer_load_dwordx4 v[40:43], v7, s[24:27], 0 offen offset:256
  buffer_load_dwordx4 v[44:47], v7, s[24:27], 0 offen offset:512
  buffer_load_dwordx4 v[48:51], v7, s[24:27], 0 offen offset:768
  buffer_load_dwordx4 v[52:55], v7, s[24:27], 0 offen offset:1024
  s_add_u32 s8, s4, 20971520
  s_addc_u32 s9, s5, 0
  s_mov_b32 s10, 262144
  s_mov_b32 s11, 0x00020000
  s_buffer_load_dword s15, s[8:11], 49152
  s_mov_b32 s28, s96
  s_mov_b32 s29, s97
  s_mov_b32 s30, 2211840
  s_mov_b32 s31, 0x00020000
  s_add_u32 s32, s4, 12582912
  s_addc_u32 s33, s5, 0
  s_mov_b32 s34, 2621440
  s_mov_b32 s35, 0x00020000
  s_mov_b32 s40, 0xffff0000
  s_mov_b32 s43, 0x3acccccd
  s_mov_b32 s44, 0x3727c5ac
  s_lshl_b32 s37, s12, 3
  v_add_u32 v8, s37, v3
  v_mul_u32_u24 v8, 1280, v8
  v_and_b32 v9, 1, v3
  v_lshlrev_b32 v9, 3, v9
  v_xor_b32 v9, v9, v4
  s_and_b32 s37, s12, 1
  s_lshl_b32 s37, s37, 2
  v_xor_b32 v9, s37, v9
  v_lshl_add_u32 v10, v9, 4, v8
  v_xor_b32 v9, 2, v9
  v_lshl_add_u32 v11, v9, 4, v8
  v_lshlrev_b32 v5, 4, v5
  s_waitcnt vmcnt(0)
  v_lshlrev_b32 v56, 16, v16
  v_lshlrev_b32 v96, 16, v36
  v_and_b32 v57, s40, v16
  v_and_b32 v97, s40, v36
  v_lshlrev_b32 v58, 16, v17
  v_lshlrev_b32 v98, 16, v37
  v_and_b32 v59, s40, v17
  v_and_b32 v99, s40, v37
  v_lshlrev_b32 v60, 16, v18
  v_lshlrev_b32 v100, 16, v38
  v_and_b32 v61, s40, v18
  v_and_b32 v101, s40, v38
  v_lshlrev_b32 v62, 16, v19
  v_lshlrev_b32 v102, 16, v39
  v_and_b32 v63, s40, v19
  v_and_b32 v103, s40, v39
  v_lshlrev_b32 v64, 16, v20
  v_lshlrev_b32 v104, 16, v40
  v_and_b32 v65, s40, v20
  v_and_b32 v105, s40, v40
  v_lshlrev_b32 v66, 16, v21
  v_lshlrev_b32 v106, 16, v41
  v_and_b32 v67, s40, v21
  v_and_b32 v107, s40, v41
  v_lshlrev_b32 v68, 16, v22
  v_lshlrev_b32 v108, 16, v42
  v_and_b32 v69, s40, v22
  v_and_b32 v109, s40, v42
  v_lshlrev_b32 v70, 16, v23
  v_lshlrev_b32 v110, 16, v43
  v_and_b32 v71, s40, v23
  v_and_b32 v111, s40, v43
  v_lshlrev_b32 v72, 16, v24
  v_lshlrev_b32 v112, 16, v44
  v_and_b32 v73, s40, v24
  v_and_b32 v113, s40, v44
  v_lshlrev_b32 v74, 16, v25
  v_lshlrev_b32 v114, 16, v45
  v_and_b32 v75, s40, v25
  v_and_b32 v115, s40, v45
  v_lshlrev_b32 v76, 16, v26
  v_lshlrev_b32 v116, 16, v46
  v_and_b32 v77, s40, v26
  v_and_b32 v117, s40, v46
  v_lshlrev_b32 v78, 16, v27
  v_lshlrev_b32 v118, 16, v47
  v_and_b32 v79, s40, v27
  v_and_b32 v119, s40, v47
  v_lshlrev_b32 v80, 16, v28
  v_lshlrev_b32 v120, 16, v48
  v_and_b32 v81, s40, v28
  v_and_b32 v121, s40, v48
  v_lshlrev_b32 v82, 16, v29
  v_lshlrev_b32 v122, 16, v49
  v_and_b32 v83, s40, v29
  v_and_b32 v123, s40, v49
  v_lshlrev_b32 v84, 16, v30
  v_lshlrev_b32 v124, 16, v50
  v_and_b32 v85, s40, v30
  v_and_b32 v125, s40, v50
  v_lshlrev_b32 v86, 16, v31
  v_lshlrev_b32 v126, 16, v51
  v_and_b32 v87, s40, v31
  v_and_b32 v127, s40, v51
  v_lshlrev_b32 v88, 16, v32
  v_lshlrev_b32 v128, 16, v52
  v_and_b32 v89, s40, v32
  v_and_b32 v129, s40, v52
  v_lshlrev_b32 v90, 16, v33
  v_lshlrev_b32 v130, 16, v53
  v_and_b32 v91, s40, v33
  v_and_b32 v131, s40, v53
  v_lshlrev_b32 v92, 16, v34
  v_lshlrev_b32 v132, 16, v54
  v_and_b32 v93, s40, v34
  v_and_b32 v133, s40, v54
  v_lshlrev_b32 v94, 16, v35
  v_lshlrev_b32 v134, 16, v55
  v_and_b32 v95, s40, v35
  v_and_b32 v135, s40, v55
  v_add_f32 v136, v56, v57
  v_add_f32 v150, v96, v97
  v_add_f32 v148, v58, v59
  v_add_f32 v158, v98, v99
  v_add_f32 v136, v136, v60
  v_add_f32 v150, v150, v100
  v_add_f32 v148, v148, v61
  v_add_f32 v158, v158, v101
  v_add_f32 v136, v136, v62
  v_add_f32 v150, v150, v102
  v_add_f32 v148, v148, v63
  v_add_f32 v158, v158, v103
  v_add_f32 v136, v136, v64
  v_add_f32 v150, v150, v104
  v_add_f32 v148, v148, v65
  v_add_f32 v158, v158, v105
  v_add_f32 v136, v136, v66
  v_add_f32 v150, v150, v106
  v_add_f32 v148, v148, v67
  v_add_f32 v158, v158, v107
  v_add_f32 v136, v136, v68
  v_add_f32 v150, v150, v108
  v_add_f32 v148, v148, v69
  v_add_f32 v158, v158, v109
  v_add_f32 v136, v136, v70
  v_add_f32 v150, v150, v110
  v_add_f32 v148, v148, v71
  v_add_f32 v158, v158, v111
  v_add_f32 v136, v136, v72
  v_add_f32 v150, v150, v112
  v_add_f32 v148, v148, v73
  v_add_f32 v158, v158, v113
  v_add_f32 v136, v136, v74
  v_add_f32 v150, v150, v114
  v_add_f32 v148, v148, v75
  v_add_f32 v158, v158, v115
  v_add_f32 v136, v136, v76
  v_add_f32 v150, v150, v116
  v_add_f32 v148, v148, v77
  v_add_f32 v158, v158, v117
  v_add_f32 v136, v136, v78
  v_add_f32 v150, v150, v118
  v_add_f32 v148, v148, v79
  v_add_f32 v158, v158, v119
  v_add_f32 v136, v136, v80
  v_add_f32 v150, v150, v120
  v_add_f32 v148, v148, v81
  v_add_f32 v158, v158, v121
  v_add_f32 v136, v136, v82
  v_add_f32 v150, v150, v122
  v_add_f32 v148, v148, v83
  v_add_f32 v158, v158, v123
  v_add_f32 v136, v136, v84
  v_add_f32 v150, v150, v124
  v_add_f32 v148, v148, v85
  v_add_f32 v158, v158, v125
  v_add_f32 v136, v136, v86
  v_add_f32 v150, v150, v126
  v_add_f32 v148, v148, v87
  v_add_f32 v158, v158, v127
  v_add_f32 v136, v136, v88
  v_add_f32 v150, v150, v128
  v_add_f32 v148, v148, v89
  v_add_f32 v158, v158, v129
  v_add_f32 v136, v136, v90
  v_add_f32 v150, v150, v130
  v_add_f32 v148, v148, v91
  v_add_f32 v158, v158, v131
  v_add_f32 v136, v136, v92
  v_add_f32 v150, v150, v132
  v_add_f32 v148, v148, v93
  v_add_f32 v158, v158, v133
  v_add_f32 v136, v136, v94
  v_add_f32 v150, v150, v134
  v_add_f32 v148, v148, v95
  v_add_f32 v158, v158, v135
  v_add_f32 v136, v136, v148
  v_add_f32 v150, v150, v158
  s_nop 0
  v_add_f32_dpp v136, v136, v136 row_ror:8 row_mask:0xf bank_mask:0xf
  v_add_f32_dpp v150, v150, v150 row_ror:8 row_mask:0xf bank_mask:0xf
  s_nop 0
  v_add_f32_dpp v136, v136, v136 row_ror:4 row_mask:0xf bank_mask:0xf
  v_add_f32_dpp v150, v150, v150 row_ror:4 row_mask:0xf bank_mask:0xf
  s_nop 0
  v_add_f32_dpp v136, v136, v136 row_ror:2 row_mask:0xf bank_mask:0xf
  v_add_f32_dpp v150, v150, v150 row_ror:2 row_mask:0xf bank_mask:0xf
  s_nop 0
  v_add_f32_dpp v136, v136, v136 row_ror:1 row_mask:0xf bank_mask:0xf
  v_add_f32_dpp v150, v150, v150 row_ror:1 row_mask:0xf bank_mask:0xf
  v_mul_f32 v137, s43, v136
  v_mul_f32 v151, s43, v150
  v_cvt_pk_bf16_f32 v139, v137, v137
  v_cvt_pk_bf16_f32 v153, v151, v151
  v_lshlrev_b32 v139, 16, v139
  v_lshlrev_b32 v153, 16, v153
  v_sub_f32 v56, v56, v139
  v_sub_f32 v96, v96, v153
  v_sub_f32 v57, v57, v139
  v_sub_f32 v97, v97, v153
  v_sub_f32 v58, v58, v139
  v_sub_f32 v98, v98, v153
  v_sub_f32 v59, v59, v139
  v_sub_f32 v99, v99, v153
  v_sub_f32 v60, v60, v139
  v_sub_f32 v100, v100, v153
  v_sub_f32 v61, v61, v139
  v_sub_f32 v101, v101, v153
  v_sub_f32 v62, v62, v139
  v_sub_f32 v102, v102, v153
  v_sub_f32 v63, v63, v139
  v_sub_f32 v103, v103, v153
  v_sub_f32 v64, v64, v139
  v_sub_f32 v104, v104, v153
  v_sub_f32 v65, v65, v139
  v_sub_f32 v105, v105, v153
  v_sub_f32 v66, v66, v139
  v_sub_f32 v106, v106, v153
  v_sub_f32 v67, v67, v139
  v_sub_f32 v107, v107, v153
  v_sub_f32 v68, v68, v139
  v_sub_f32 v108, v108, v153
  v_sub_f32 v69, v69, v139
  v_sub_f32 v109, v109, v153
  v_sub_f32 v70, v70, v139
  v_sub_f32 v110, v110, v153
  v_sub_f32 v71, v71, v139
  v_sub_f32 v111, v111, v153
  v_sub_f32 v72, v72, v139
  v_sub_f32 v112, v112, v153
  v_sub_f32 v73, v73, v139
  v_sub_f32 v113, v113, v153
  v_sub_f32 v74, v74, v139
  v_sub_f32 v114, v114, v153
  v_sub_f32 v75, v75, v139
  v_sub_f32 v115, v115, v153
  v_sub_f32 v76, v76, v139
  v_sub_f32 v116, v116, v153
  v_sub_f32 v77, v77, v139
  v_sub_f32 v117, v117, v153
  v_sub_f32 v78, v78, v139
  v_sub_f32 v118, v118, v153
  v_sub_f32 v79, v79, v139
  v_sub_f32 v119, v119, v153
  v_sub_f32 v80, v80, v139
  v_sub_f32 v120, v120, v153
  v_sub_f32 v81, v81, v139
  v_sub_f32 v121, v121, v153
  v_sub_f32 v82, v82, v139
  v_sub_f32 v122, v122, v153
  v_sub_f32 v83, v83, v139
  v_sub_f32 v123, v123, v153
  v_sub_f32 v84, v84, v139
  v_sub_f32 v124, v124, v153
  v_sub_f32 v85, v85, v139
  v_sub_f32 v125, v125, v153
  v_sub_f32 v86, v86, v139
  v_sub_f32 v126, v126, v153
  v_sub_f32 v87, v87, v139
  v_sub_f32 v127, v127, v153
  v_sub_f32 v88, v88, v139
  v_sub_f32 v128, v128, v153
  v_sub_f32 v89, v89, v139
  v_sub_f32 v129, v129, v153
  v_sub_f32 v90, v90, v139
  v_sub_f32 v130, v130, v153
  v_sub_f32 v91, v91, v139
  v_sub_f32 v131, v131, v153
  v_sub_f32 v92, v92, v139
  v_sub_f32 v132, v132, v153
  v_sub_f32 v93, v93, v139
  v_sub_f32 v133, v133, v153
  v_sub_f32 v94, v94, v139
  v_sub_f32 v134, v134, v153
  v_sub_f32 v95, v95, v139
  v_sub_f32 v135, v135, v153
  v_mul_f32 v148, v56, v56
  v_mul_f32 v158, v96, v96
  v_mul_f32 v149, v57, v57
  v_mul_f32 v159, v97, v97
  v_fmac_f32 v148, v58, v58
  v_fmac_f32 v158, v98, v98
  v_fmac_f32 v149, v59, v59
  v_fmac_f32 v159, v99, v99
  v_fmac_f32 v148, v60, v60
  v_fmac_f32 v158, v100, v100
  v_fmac_f32 v149, v61, v61
  v_fmac_f32 v159, v101, v101
  v_fmac_f32 v148, v62, v62
  v_fmac_f32 v158, v102, v102
  v_fmac_f32 v149, v63, v63
  v_fmac_f32 v159, v103, v103
  v_fmac_f32 v148, v64, v64
  v_fmac_f32 v158, v104, v104
  v_fmac_f32 v149, v65, v65
  v_fmac_f32 v159, v105, v105
  v_fmac_f32 v148, v66, v66
  v_fmac_f32 v158, v106, v106
  v_fmac_f32 v149, v67, v67
  v_fmac_f32 v159, v107, v107
  v_fmac_f32 v148, v68, v68
  v_fmac_f32 v158, v108, v108
  v_fmac_f32 v149, v69, v69
  v_fmac_f32 v159, v109, v109
  v_fmac_f32 v148, v70, v70
  v_fmac_f32 v158, v110, v110
  v_fmac_f32 v149, v71, v71
  v_fmac_f32 v159, v111, v111
  v_fmac_f32 v148, v72, v72
  v_fmac_f32 v158, v112, v112
  v_fmac_f32 v149, v73, v73
  v_fmac_f32 v159, v113, v113
  v_fmac_f32 v148, v74, v74
  v_fmac_f32 v158, v114, v114
  v_fmac_f32 v149, v75, v75
  v_fmac_f32 v159, v115, v115
  v_fmac_f32 v148, v76, v76
  v_fmac_f32 v158, v116, v116
  v_fmac_f32 v149, v77, v77
  v_fmac_f32 v159, v117, v117
  v_fmac_f32 v148, v78, v78
  v_fmac_f32 v158, v118, v118
  v_fmac_f32 v149, v79, v79
  v_fmac_f32 v159, v119, v119
  v_fmac_f32 v148, v80, v80
  v_fmac_f32 v158, v120, v120
  v_fmac_f32 v149, v81, v81
  v_fmac_f32 v159, v121, v121
  v_fmac_f32 v148, v82, v82
  v_fmac_f32 v158, v122, v122
  v_fmac_f32 v149, v83, v83
  v_fmac_f32 v159, v123, v123
  v_fmac_f32 v148, v84, v84
  v_fmac_f32 v158, v124, v124
  v_fmac_f32 v149, v85, v85
  v_fmac_f32 v159, v125, v125
  v_fmac_f32 v148, v86, v86
  v_fmac_f32 v158, v126, v126
  v_fmac_f32 v149, v87, v87
  v_fmac_f32 v159, v127, v127
  v_fmac_f32 v148, v88, v88
  v_fmac_f32 v158, v128, v128
  v_fmac_f32 v149, v89, v89
  v_fmac_f32 v159, v129, v129
  v_fmac_f32 v148, v90, v90
  v_fmac_f32 v158, v130, v130
  v_fmac_f32 v149, v91, v91
  v_fmac_f32 v159, v131, v131
  v_fmac_f32 v148, v92, v92
  v_fmac_f32 v158, v132, v132
  v_fmac_f32 v149, v93, v93
  v_fmac_f32 v159, v133, v133
  v_fmac_f32 v148, v94, v94
  v_fmac_f32 v158, v134, v134
  v_fmac_f32 v149, v95, v95
  v_fmac_f32 v159, v135, v135
  v_add_f32 v138, v148, v149
  v_add_f32 v152, v158, v159
  s_nop 0
  v_add_f32_dpp v138, v138, v138 row_ror:8 row_mask:0xf bank_mask:0xf
  v_add_f32_dpp v152, v152, v152 row_ror:8 row_mask:0xf bank_mask:0xf
  s_nop 0
  v_add_f32_dpp v138, v138, v138 row_ror:4 row_mask:0xf bank_mask:0xf
  v_add_f32_dpp v152, v152, v152 row_ror:4 row_mask:0xf bank_mask:0xf
  s_nop 0
  v_add_f32_dpp v138, v138, v138 row_ror:2 row_mask:0xf bank_mask:0xf
  v_add_f32_dpp v152, v152, v152 row_ror:2 row_mask:0xf bank_mask:0xf
  s_nop 0
  v_add_f32_dpp v138, v138, v138 row_ror:1 row_mask:0xf bank_mask:0xf
  v_add_f32_dpp v152, v152, v152 row_ror:1 row_mask:0xf bank_mask:0xf
  v_sub_f32 v140, v137, v139
  v_sub_f32 v154, v151, v153
  v_mul_f32 v138, s43, v138
  v_mul_f32 v152, s43, v152
  v_fma_f32 v138, -v140, v140, v138
  v_fma_f32 v152, -v154, v154, v152
  v_max_f32 v138, 0, v138
  v_max_f32 v152, 0, v152
  v_cvt_pk_bf16_f32 v139, v138, v138
  v_cvt_pk_bf16_f32 v153, v152, v152
  v_lshlrev_b32 v139, 16, v139
  v_lshlrev_b32 v153, 16, v153
  v_add_f32 v139, s44, v139
  v_add_f32 v153, s44, v153
  v_cvt_pk_bf16_f32 v139, v139, v139
  v_cvt_pk_bf16_f32 v153, v153, v153
  v_lshlrev_b32 v139, 16, v139
  v_lshlrev_b32 v153, 16, v153
  v_sqrt_f32 v139, v139
  v_sqrt_f32 v153, v153
  v_cvt_pk_bf16_f32 v139, v139, v139
  v_cvt_pk_bf16_f32 v153, v153, v153
  v_lshlrev_b32 v139, 16, v139
  v_lshlrev_b32 v153, 16, v153
  v_rcp_f32 v142, v139
  v_rcp_f32 v156, v153
  buffer_load_dwordx4 v[160:163], v15, s[28:31], s36 offen
  s_add_u32 s36, s36, 55296
  buffer_load_dwordx4 v[164:167], v15, s[28:31], s36 offen
  s_add_u32 s36, s36, 55296
  buffer_load_dwordx4 v[168:171], v15, s[28:31], s36 offen
  s_add_u32 s36, s36, 55296
  buffer_load_dwordx4 v[172:175], v15, s[28:31], s36 offen
  s_add_u32 s36, s36, 55296
  buffer_load_dwordx4 v[176:179], v15, s[28:31], s36 offen
  s_add_u32 s36, s36, 55296
  buffer_load_dwordx4 v[180:183], v15, s[28:31], s36 offen
  s_add_u32 s36, s36, 55296
  buffer_load_dwordx4 v[184:187], v15, s[28:31], s36 offen
  s_add_u32 s36, s36, 55296
  buffer_load_dwordx4 v[188:191], v15, s[28:31], s36 offen
  s_add_u32 s36, s36, 55296
  buffer_load_dwordx4 v[192:195], v15, s[28:31], s36 offen
  s_add_u32 s36, s36, 55296
  buffer_load_dwordx4 v[196:199], v15, s[28:31], s36 offen
  s_add_u32 s36, s36, 55296
  v_mul_f32 v56, v56, v142
  v_mul_f32 v96, v96, v156
  v_mul_f32 v57, v57, v142
  v_mul_f32 v97, v97, v156
  v_mul_f32 v58, v58, v142
  v_mul_f32 v98, v98, v156
  v_mul_f32 v59, v59, v142
  v_mul_f32 v99, v99, v156
  v_mul_f32 v60, v60, v142
  v_mul_f32 v100, v100, v156
  v_mul_f32 v61, v61, v142
  v_mul_f32 v101, v101, v156
  v_mul_f32 v62, v62, v142
  v_mul_f32 v102, v102, v156
  v_mul_f32 v63, v63, v142
  v_mul_f32 v103, v103, v156
  v_mul_f32 v64, v64, v142
  v_mul_f32 v104, v104, v156
  v_mul_f32 v65, v65, v142
  v_mul_f32 v105, v105, v156
  v_mul_f32 v66, v66, v142
  v_mul_f32 v106, v106, v156
  v_mul_f32 v67, v67, v142
  v_mul_f32 v107, v107, v156
  v_mul_f32 v68, v68, v142
  v_mul_f32 v108, v108, v156
  v_mul_f32 v69, v69, v142
  v_mul_f32 v109, v109, v156
  v_mul_f32 v70, v70, v142
  v_mul_f32 v110, v110, v156
  v_mul_f32 v71, v71, v142
  v_mul_f32 v111, v111, v156
  v_mul_f32 v72, v72, v142
  v_mul_f32 v112, v112, v156
  v_mul_f32 v73, v73, v142
  v_mul_f32 v113, v113, v156
  v_mul_f32 v74, v74, v142
  v_mul_f32 v114, v114, v156
  v_mul_f32 v75, v75, v142
  v_mul_f32 v115, v115, v156
  v_mul_f32 v76, v76, v142
  v_mul_f32 v116, v116, v156
  v_mul_f32 v77, v77, v142
  v_mul_f32 v117, v117, v156
  v_mul_f32 v78, v78, v142
  v_mul_f32 v118, v118, v156
  v_mul_f32 v79, v79, v142
  v_mul_f32 v119, v119, v156
  v_mul_f32 v80, v80, v142
  v_mul_f32 v120, v120, v156
  v_mul_f32 v81, v81, v142
  v_mul_f32 v121, v121, v156
  v_mul_f32 v82, v82, v142
  v_mul_f32 v122, v122, v156
  v_mul_f32 v83, v83, v142
  v_mul_f32 v123, v123, v156
  v_mul_f32 v84, v84, v142
  v_mul_f32 v124, v124, v156
  v_mul_f32 v85, v85, v142
  v_mul_f32 v125, v125, v156
  v_mul_f32 v86, v86, v142
  v_mul_f32 v126, v126, v156
  v_mul_f32 v87, v87, v142
  v_mul_f32 v127, v127, v156
  v_mul_f32 v88, v88, v142
  v_mul_f32 v128, v128, v156
  v_mul_f32 v89, v89, v142
  v_mul_f32 v129, v129, v156
  v_mul_f32 v90, v90, v142
  v_mul_f32 v130, v130, v156
  v_mul_f32 v91, v91, v142
  v_mul_f32 v131, v131, v156
  v_mul_f32 v92, v92, v142
  v_mul_f32 v132, v132, v156
  v_mul_f32 v93, v93, v142
  v_mul_f32 v133, v133, v156
  v_mul_f32 v94, v94, v142
  v_mul_f32 v134, v134, v156
  v_mul_f32 v95, v95, v142
  v_mul_f32 v135, v135, v156
  v_cvt_pk_bf16_f32 v16, v56, v57
  v_cvt_pk_bf16_f32 v36, v96, v97
  v_cvt_pk_bf16_f32 v17, v58, v59
  v_cvt_pk_bf16_f32 v37, v98, v99
  v_cvt_pk_bf16_f32 v18, v60, v61
  v_cvt_pk_bf16_f32 v38, v100, v101
  v_cvt_pk_bf16_f32 v19, v62, v63
  v_cvt_pk_bf16_f32 v39, v102, v103
  v_cvt_pk_bf16_f32 v20, v64, v65
  v_cvt_pk_bf16_f32 v40, v104, v105
  v_cvt_pk_bf16_f32 v21, v66, v67
  v_cvt_pk_bf16_f32 v41, v106, v107
  v_cvt_pk_bf16_f32 v22, v68, v69
  v_cvt_pk_bf16_f32 v42, v108, v109
  v_cvt_pk_bf16_f32 v23, v70, v71
  v_cvt_pk_bf16_f32 v43, v110, v111
  v_cvt_pk_bf16_f32 v24, v72, v73
  v_cvt_pk_bf16_f32 v44, v112, v113
  v_cvt_pk_bf16_f32 v25, v74, v75
  v_cvt_pk_bf16_f32 v45, v114, v115
  v_cvt_pk_bf16_f32 v26, v76, v77
  v_cvt_pk_bf16_f32 v46, v116, v117
  v_cvt_pk_bf16_f32 v27, v78, v79
  v_cvt_pk_bf16_f32 v47, v118, v119
  v_cvt_pk_bf16_f32 v28, v80, v81
  v_cvt_pk_bf16_f32 v48, v120, v121
  v_cvt_pk_bf16_f32 v29, v82, v83
  v_cvt_pk_bf16_f32 v49, v122, v123
  v_cvt_pk_bf16_f32 v30, v84, v85
  v_cvt_pk_bf16_f32 v50, v124, v125
  v_cvt_pk_bf16_f32 v31, v86, v87
  v_cvt_pk_bf16_f32 v51, v126, v127
  v_cvt_pk_bf16_f32 v32, v88, v89
  v_cvt_pk_bf16_f32 v52, v128, v129
  v_cvt_pk_bf16_f32 v33, v90, v91
  v_cvt_pk_bf16_f32 v53, v130, v131
  v_cvt_pk_bf16_f32 v34, v92, v93
  v_cvt_pk_bf16_f32 v54, v132, v133
  v_cvt_pk_bf16_f32 v35, v94, v95
  v_cvt_pk_bf16_f32 v55, v134, v135
  ds_write_b128 v10, v[16:19] offset:0
  ds_write_b128 v11, v[36:39] offset:5120
  ds_write_b128 v10, v[20:23] offset:256
  ds_write_b128 v11, v[40:43] offset:5376
  ds_write_b128 v10, v[24:27] offset:512
  ds_write_b128 v11, v[44:47] offset:5632
  ds_write_b128 v10, v[28:31] offset:768
  ds_write_b128 v11, v[48:51] offset:5888
  ds_write_b128 v10, v[32:35] offset:1024
  ds_write_b128 v11, v[52:55] offset:6144
  v_bfe_u32 v9, v2, 2, 2
  v_and_b32 v10, 3, v2
  v_lshl_add_u32 v11, v9, 2, v3
  v_mul_u32_u24 v11, 1280, v11
  v_and_b32 v12, 1, v10
  v_lshl_add_u32 v11, v12, 3, v11
  v_and_b32 v12, 1, v3
  v_lshl_add_u32 v12, v12, 2, v9
  v_lshlrev_b32 v12, 1, v12
  v_lshrrev_b32 v13, 1, v10
  s_mul_i32 s37, s12, 20
  v_add_u32 v13, s37, v13
  v_add_u32 v14, 0, v13
  v_xor_b32 v14, v14, v12
  v_lshl_add_u32 v56, v14, 4, v11
  v_add_u32 v14, 2, v13
  v_xor_b32 v14, v14, v12
  v_lshl_add_u32 v57, v14, 4, v11
  v_add_u32 v14, 4, v13
  v_xor_b32 v14, v14, v12
  v_lshl_add_u32 v58, v14, 4, v11
  v_add_u32 v14, 6, v13
  v_xor_b32 v14, v14, v12
  v_lshl_add_u32 v59, v14, 4, v11
  v_add_u32 v14, 8, v13
  v_xor_b32 v14, v14, v12
  v_lshl_add_u32 v60, v14, 4, v11
  v_add_u32 v14, 10, v13
  v_xor_b32 v14, v14, v12
  v_lshl_add_u32 v61, v14, 4, v11
  v_add_u32 v14, 12, v13
  v_xor_b32 v14, v14, v12
  v_lshl_add_u32 v62, v14, 4, v11
  v_add_u32 v14, 14, v13
  v_xor_b32 v14, v14, v12
  v_lshl_add_u32 v63, v14, 4, v11
  v_add_u32 v14, 16, v13
  v_xor_b32 v14, v14, v12
  v_lshl_add_u32 v64, v14, 4, v11
  v_add_u32 v14, 18, v13
  v_xor_b32 v14, v14, v12
  v_lshl_add_u32 v65, v14, 4, v11
  v_mul_u32_u24 v14, 10240, v3
  v_lshl_add_u32 v14, v4, 4, v14
  s_mul_i32 s38, s22, 40960
  s_mul_i32 s37, s12, 2560
  s_add_u32 s38, s38, s37
  s_waitcnt lgkmcnt(0)
  s_barrier
  ds_read_b64_tr_b16 v[16:17], v56
  ds_read_b64_tr_b16 v[18:19], v56 offset:20480
  ds_read_b64_tr_b16 v[20:21], v57
  ds_read_b64_tr_b16 v[22:23], v57 offset:20480
  ds_read_b64_tr_b16 v[24:25], v58
  ds_read_b64_tr_b16 v[26:27], v58 offset:20480
  ds_read_b64_tr_b16 v[28:29], v59
  ds_read_b64_tr_b16 v[30:31], v59 offset:20480
  ds_read_b64_tr_b16 v[32:33], v60
  ds_read_b64_tr_b16 v[34:35], v60 offset:20480
  ds_read_b64_tr_b16 v[36:37], v61
  ds_read_b64_tr_b16 v[38:39], v61 offset:20480
  ds_read_b64_tr_b16 v[40:41], v62
  ds_read_b64_tr_b16 v[42:43], v62 offset:20480
  ds_read_b64_tr_b16 v[44:45], v63
  ds_read_b64_tr_b16 v[46:47], v63 offset:20480
  ds_read_b64_tr_b16 v[48:49], v64
  ds_read_b64_tr_b16 v[50:51], v64 offset:20480
  ds_read_b64_tr_b16 v[52:53], v65
  ds_read_b64_tr_b16 v[54:55], v65 offset:20480
  s_waitcnt lgkmcnt(15)
  buffer_store_dwordx4 v[16:19], v14, s[32:35], s38 offen offset:0 sc1
  buffer_store_dwordx4 v[20:23], v14, s[32:35], s38 offen offset:256 sc1
  s_waitcnt lgkmcnt(12)
  buffer_store_dwordx4 v[24:27], v14, s[32:35], s38 offen offset:512 sc1
  buffer_store_dwordx4 v[28:31], v14, s[32:35], s38 offen offset:768 sc1
  s_waitcnt lgkmcnt(8)
  buffer_store_dwordx4 v[32:35], v14, s[32:35], s38 offen offset:1024 sc1
  buffer_store_dwordx4 v[36:39], v14, s[32:35], s38 offen offset:1280 sc1
  s_waitcnt lgkmcnt(4)
  buffer_store_dwordx4 v[40:43], v14, s[32:35], s38 offen offset:1536 sc1
  buffer_store_dwordx4 v[44:47], v14, s[32:35], s38 offen offset:1792 sc1
  s_waitcnt lgkmcnt(0)
  buffer_store_dwordx4 v[48:51], v14, s[32:35], s38 offen offset:2048 sc1
  buffer_store_dwordx4 v[52:55], v14, s[32:35], s38 offen offset:2304 sc1
  s_add_u32 s15, s15, 1
  v_mul_f32 v140, v142, v142
  v_mul_f32 v154, v156, v156
  v_mul_f32 v140, v140, v138
  v_mul_f32 v154, v154, v152
  v_cvt_pk_bf16_f32 v140, v140, v140
  v_cvt_pk_bf16_f32 v154, v154, v154
  v_lshlrev_b32 v140, 16, v140
  v_lshlrev_b32 v154, 16, v154
  v_add_f32 v140, s44, v140
  v_add_f32 v154, s44, v154
  v_cvt_pk_bf16_f32 v140, v140, v140
  v_cvt_pk_bf16_f32 v154, v154, v154
  v_lshlrev_b32 v140, 16, v140
  v_lshlrev_b32 v154, 16, v154
  v_sqrt_f32 v140, v140
  v_sqrt_f32 v154, v154
  v_cvt_pk_bf16_f32 v140, v140, v140
  v_cvt_pk_bf16_f32 v154, v154, v154
  v_lshlrev_b32 v140, 16, v140
  v_lshlrev_b32 v154, 16, v154
  v_mul_f32 v136, v139, v140
  v_mul_f32 v150, v153, v154
  v_rcp_f32 v146, v136
  v_rcp_f32 v202, v150
  v_cvt_pk_bf16_f32 v144, -v137, v136
  v_cvt_pk_bf16_f32 v200, -v151, v150
  v_and_b32 v140, 0xffff0000, v144
  v_and_b32 v154, 0xffff0000, v200
  v_sub_f32 v140, v136, v140
  v_sub_f32 v154, v150, v154
  v_cvt_pk_bf16_f32 v145, v140, 0
  v_cvt_pk_bf16_f32 v201, v154, 0
  v_mov_b32 v147, s15
  v_mov_b32 v203, s15
  v_cmp_eq_u32 vcc, 0, v4
  s_nop 0
  s_and_saveexec_b64 s[38:39], vcc
  buffer_store_dwordx4 v[144:147], v5, s[8:11], 0 offen sc1
  buffer_store_dwordx4 v[200:203], v5, s[8:11], 0 offen offset:64 sc1
  s_mov_b64 exec, s[38:39]
  s_lshl_b32 s37, s22, 2
  s_add_u32 s37, s37, 65536
  v_lshlrev_b32 v251, 8, v2
  s_mov_b32 s45, s37
  s_waitcnt vmcnt(12)
  v_lshlrev_b32 v70, 16, v160
  v_and_b32 v71, s40, v160
  v_lshlrev_b32 v72, 16, v161
  v_and_b32 v73, s40, v161
  v_lshlrev_b32 v74, 16, v162
  v_and_b32 v75, s40, v162
  v_lshlrev_b32 v76, 16, v163
  v_and_b32 v77, s40, v163
  v_lshlrev_b32 v80, 16, v164
  v_and_b32 v81, s40, v164
  v_add_f32 v70, v70, v80
  v_add_f32 v71, v71, v81
  v_lshlrev_b32 v82, 16, v165
  v_and_b32 v83, s40, v165
  v_add_f32 v72, v72, v82
  v_add_f32 v73, v73, v83
  v_lshlrev_b32 v84, 16, v166
  v_and_b32 v85, s40, v166
  v_add_f32 v74, v74, v84
  v_add_f32 v75, v75, v85
  v_lshlrev_b32 v86, 16, v167
  v_and_b32 v87, s40, v167
  v_add_f32 v76, v76, v86
  v_add_f32 v77, v77, v87
  v_lshlrev_b32 v80, 16, v168
  v_and_b32 v81, s40, v168
  v_add_f32 v70, v70, v80
  v_add_f32 v71, v71, v81
  v_lshlrev_b32 v82, 16, v169
  v_and_b32 v83, s40, v169
  v_add_f32 v72, v72, v82
  v_add_f32 v73, v73, v83
  v_lshlrev_b32 v84, 16, v170
  v_and_b32 v85, s40, v170
  v_add_f32 v74, v74, v84
  v_add_f32 v75, v75, v85
  v_lshlrev_b32 v86, 16, v171
  v_and_b32 v87, s40, v171
  v_add_f32 v76, v76, v86
  v_add_f32 v77, v77, v87
  v_lshlrev_b32 v80, 16, v172
  v_and_b32 v81, s40, v172
  v_add_f32 v70, v70, v80
  v_add_f32 v71, v71, v81
  v_lshlrev_b32 v82, 16, v173
  v_and_b32 v83, s40, v173
  v_add_f32 v72, v72, v82
  v_add_f32 v73, v73, v83
  v_lshlrev_b32 v84, 16, v174
  v_and_b32 v85, s40, v174
  v_add_f32 v74, v74, v84
  v_add_f32 v75, v75, v85
  v_lshlrev_b32 v86, 16, v175
  v_and_b32 v87, s40, v175
  v_add_f32 v76, v76, v86
  v_add_f32 v77, v77, v87
  v_lshlrev_b32 v80, 16, v176
  v_and_b32 v81, s40, v176
  v_add_f32 v70, v70, v80
  v_add_f32 v71, v71, v81
  v_lshlrev_b32 v82, 16, v177
  v_and_b32 v83, s40, v177
  v_add_f32 v72, v72, v82
  v_add_f32 v73, v73, v83
  v_lshlrev_b32 v84, 16, v178
  v_and_b32 v85, s40, v178
  v_add_f32 v74, v74, v84
  v_add_f32 v75, v75, v85
  v_lshlrev_b32 v86, 16, v179
  v_and_b32 v87, s40, v179
  v_add_f32 v76, v76, v86
  v_add_f32 v77, v77, v87
  v_lshlrev_b32 v80, 16, v180
  v_and_b32 v81, s40, v180
  v_add_f32 v70, v70, v80
  v_add_f32 v71, v71, v81
  v_lshlrev_b32 v82, 16, v181
  v_and_b32 v83, s40, v181
  v_add_f32 v72, v72, v82
  v_add_f32 v73, v73, v83
  v_lshlrev_b32 v84, 16, v182
  v_and_b32 v85, s40, v182
  v_add_f32 v74, v74, v84
  v_add_f32 v75, v75, v85
  v_lshlrev_b32 v86, 16, v183
  v_and_b32 v87, s40, v183
  v_add_f32 v76, v76, v86
  v_add_f32 v77, v77, v87
  v_lshlrev_b32 v80, 16, v184
  v_and_b32 v81, s40, v184
  v_add_f32 v70, v70, v80
  v_add_f32 v71, v71, v81
  v_lshlrev_b32 v82, 16, v185
  v_and_b32 v83, s40, v185
  v_add_f32 v72, v72, v82
  v_add_f32 v73, v73, v83
  v_lshlrev_b32 v84, 16, v186
  v_and_b32 v85, s40, v186
  v_add_f32 v74, v74, v84
  v_add_f32 v75, v75, v85
  v_lshlrev_b32 v86, 16, v187
  v_and_b32 v87, s40, v187
  v_add_f32 v76, v76, v86
  v_add_f32 v77, v77, v87
  v_lshlrev_b32 v80, 16, v188
  v_and_b32 v81, s40, v188
  v_add_f32 v70, v70, v80
  v_add_f32 v71, v71, v81
  v_lshlrev_b32 v82, 16, v189
  v_and_b32 v83, s40, v189
  v_add_f32 v72, v72, v82
  v_add_f32 v73, v73, v83
  v_lshlrev_b32 v84, 16, v190
  v_and_b32 v85, s40, v190
  v_add_f32 v74, v74, v84
  v_add_f32 v75, v75, v85
  v_lshlrev_b32 v86, 16, v191
  v_and_b32 v87, s40, v191
  v_add_f32 v76, v76, v86
  v_add_f32 v77, v77, v87
  v_lshlrev_b32 v80, 16, v192
  v_and_b32 v81, s40, v192
  v_add_f32 v70, v70, v80
  v_add_f32 v71, v71, v81
  v_lshlrev_b32 v82, 16, v193
  v_and_b32 v83, s40, v193
  v_add_f32 v72, v72, v82
  v_add_f32 v73, v73, v83
  v_lshlrev_b32 v84, 16, v194
  v_and_b32 v85, s40, v194
  v_add_f32 v74, v74, v84
  v_add_f32 v75, v75, v85
  v_lshlrev_b32 v86, 16, v195
  v_and_b32 v87, s40, v195
  v_add_f32 v76, v76, v86
  v_add_f32 v77, v77, v87
  v_lshlrev_b32 v80, 16, v196
  v_and_b32 v81, s40, v196
  v_add_f32 v70, v70, v80
  v_add_f32 v71, v71, v81
  v_lshlrev_b32 v82, 16, v197
  v_and_b32 v83, s40, v197
  v_add_f32 v72, v72, v82
  v_add_f32 v73, v73, v83
  v_lshlrev_b32 v84, 16, v198
  v_and_b32 v85, s40, v198
  v_add_f32 v74, v74, v84
  v_add_f32 v75, v75, v85
  v_lshlrev_b32 v86, 16, v199
  v_and_b32 v87, s40, v199
  v_add_f32 v76, v76, v86
  v_add_f32 v77, v77, v87
  v_add_f32_dpp v70, v70, v70 row_ror:8 row_mask:0xf bank_mask:0xf
  v_add_f32_dpp v71, v71, v71 row_ror:8 row_mask:0xf bank_mask:0xf
  v_add_f32_dpp v72, v72, v72 row_ror:8 row_mask:0xf bank_mask:0xf
  v_add_f32_dpp v73, v73, v73 row_ror:8 row_mask:0xf bank_mask:0xf
  v_add_f32_dpp v74, v74, v74 row_ror:8 row_mask:0xf bank_mask:0xf
  v_add_f32_dpp v75, v75, v75 row_ror:8 row_mask:0xf bank_mask:0xf
  v_add_f32_dpp v76, v76, v76 row_ror:8 row_mask:0xf bank_mask:0xf
  v_add_f32_dpp v77, v77, v77 row_ror:8 row_mask:0xf bank_mask:0xf
  v_add_f32_dpp v70, v70, v70 row_ror:4 row_mask:0xf bank_mask:0xf
  v_add_f32_dpp v71, v71, v71 row_ror:4 row_mask:0xf bank_mask:0xf
  v_add_f32_dpp v72, v72, v72 row_ror:4 row_mask:0xf bank_mask:0xf
  v_add_f32_dpp v73, v73, v73 row_ror:4 row_mask:0xf bank_mask:0xf
  v_add_f32_dpp v74, v74, v74 row_ror:4 row_mask:0xf bank_mask:0xf
  v_add_f32_dpp v75, v75, v75 row_ror:4 row_mask:0xf bank_mask:0xf
  v_add_f32_dpp v76, v76, v76 row_ror:4 row_mask:0xf bank_mask:0xf
  v_add_f32_dpp v77, v77, v77 row_ror:4 row_mask:0xf bank_mask:0xf
  s_lshl_b32 s37, s12, 9
  v_lshlrev_b32 v9, 7, v3
  v_lshl_add_u32 v9, v10, 5, v9
  v_add_u32 v9, s37, v9
  v_and_b32 v12, 12, v2
  v_cmp_eq_u32 vcc, 0, v12
  s_nop 0
  s_and_saveexec_b64 s[38:39], vcc
  ds_write_b128 v9, v[70:73] offset:40960
  ds_write_b128 v9, v[74:77] offset:40976
  s_mov_b64 exec, s[38:39]
  s_waitcnt vmcnt(2) lgkmcnt(0)
  s_barrier
  s_cmp_lg_u32 s12, 0
  s_cbranch_scc1 Lsig_19
  v_mov_b32 v250, s15
  buffer_store_dword v250, v251, s[8:11], s45 offen sc1
Lsig_19:
  s_cmp_lg_u32 s12, 1
  s_cbranch_scc1 L_ln_cs
  v_and_b32 v9, 31, v2
  v_lshrrev_b32 v12, 5, v2
  v_lshlrev_b32 v12, 10, v12
  v_lshl_add_u32 v12, v9, 2, v12
  ds_read_b32 v70, v12 offset:40960
  ds_read_b32 v71, v12 offset:41088
  ds_read_b32 v72, v12 offset:41216
  ds_read_b32 v73, v12 offset:41344
  ds_read_b32 v74, v12 offset:41472
  ds_read_b32 v75, v12 offset:41600
  ds_read_b32 v76, v12 offset:41728
  ds_read_b32 v77, v12 offset:41856
  s_waitcnt lgkmcnt(0)
  v_add_f32 v70, v70, v71
  v_add_f32 v70, v70, v72
  v_add_f32 v70, v70, v73
  v_add_f32 v70, v70, v74
  v_add_f32 v70, v70, v75
  v_add_f32 v70, v70, v76
  v_add_f32 v70, v70, v77
  v_mov_b32 v71, v70
  s_nop 1
  v_permlane32_swap_b32 v70, v71
  v_add_f32 v70, v70, v71
  v_mov_b32 v71, s15
  s_lshl_b32 s37, s18, 8
  s_add_u32 s37, s37, 32768
  s_cmp_lt_u32 s18, 54
  s_cselect_b32 s37, s37, 0x40000000
  v_lshlrev_b32 v9, 3, v9
  buffer_store_dwordx2 v[70:71], v9, s[8:11], s37 offen sc1
L_ln_cs:
  s_cmp_lt_u32 s21, 2
  s_cbranch_scc1 L_ln_g2
  s_cmp_lg_u32 s2, 31
  s_cbranch_scc1 L_exit
  s_cmp_lg_u32 s12, 0
  s_cbranch_scc1 L_exit
  v_min_u32 v3, 53, v2
  v_lshlrev_b32 v3, 4, v3
  v_min_u32 v4, 55, v2
  v_lshlrev_b32 v4, 4, v4
  v_lshlrev_b32 v5, 2, v2
  s_mov_b32 s22, 50176
  buffer_load_dwordx4 v[240:243], v4, s[8:11], s22 offen sc1
  s_waitcnt vmcnt(0)
  s_bitcmp1_b32 s3, 13
  s_cbranch_scc0 Lpd_21
  s_mov_b32 s91, 0
Lpl_20:
  v_cmp_ne_u32 vcc, s15, v240
  v_cmp_ne_u32 s[88:89], s15, v241
  s_nop 0
  s_or_b64 vcc, vcc, s[88:89]
  v_cmp_ne_u32 s[88:89], s15, v242
  s_nop 0
  s_or_b64 vcc, vcc, s[88:89]
  v_cmp_ne_u32 s[88:89], s15, v243
  s_nop 0
  s_or_b64 vcc, vcc, s[88:89]
  s_add_u32 s91, s91, 1
  s_cmp_eq_u64 vcc, 0
  s_cbranch_scc1 Lpd_21
  s_sleep 32
  buffer_load_dwordx4 v[240:243], v4, s[8:11], s22 offen sc1
  s_waitcnt vmcnt(0)
  s_cmp_lt_u32 s91, 8192
  s_cbranch_scc1 Lpl_20
Lpd_21:
  s_mov_b32 s22, 229376
  buffer_load_dwordx4 v[240:243], v3, s[8:11], s22 offen sc1
  s_waitcnt vmcnt(0)
  s_bitcmp1_b32 s3, 13
  s_cbranch_scc0 Lpd_23
  s_mov_b32 s91, 0
Lpl_22:
  v_cmp_ne_u32 vcc, s15, v240
  v_cmp_ne_u32 s[88:89], s15, v241
  s_nop 0
  s_or_b64 vcc, vcc, s[88:89]
  v_cmp_ne_u32 s[88:89], s15, v242
  s_nop 0
  s_or_b64 vcc, vcc, s[88:89]
  v_cmp_ne_u32 s[88:89], s15, v243
  s_nop 0
  s_or_b64 vcc, vcc, s[88:89]
  s_add_u32 s91, s91, 1
  s_cmp_eq_u64 vcc, 0
  s_cbranch_scc1 Lpd_23
  s_sleep 32
  buffer_load_dwordx4 v[240:243], v3, s[8:11], s22 offen sc1
  s_waitcnt vmcnt(0)
  s_cmp_lt_u32 s91, 8192
  s_cbranch_scc1 Lpl_22
Lpd_23:
  s_mov_b32 s22, 230400
  buffer_load_dwordx4 v[240:243], v3, s[8:11], s22 offen sc1
  s_waitcnt vmcnt(0)
  s_bitcmp1_b32 s3, 13
  s_cbranch_scc0 Lpd_25
  s_mov_b32 s91, 0
Lpl_24:
  v_cmp_ne_u32 vcc, s15, v240
  v_cmp_ne_u32 s[88:89], s15, v241
  s_nop 0
  s_or_b64 vcc, vcc, s[88:89]
  v_cmp_ne_u32 s[88:89], s15, v242
  s_nop 0
  s_or_b64 vcc, vcc, s[88:89]
  v_cmp_ne_u32 s[88:89], s15, v243
  s_nop 0
  s_or_b64 vcc, vcc, s[88:89]
  s_add_u32 s91, s91, 1
  s_cmp_eq_u64 vcc, 0
  s_cbranch_scc1 Lpd_25
  s_sleep 32
  buffer_load_dwordx4 v[240:243], v3, s[8:11], s22 offen sc1
  s_waitcnt vmcnt(0)
  s_cmp_lt_u32 s91, 8192
  s_cbranch_scc1 Lpl_24
Lpd_25:
  s_mov_b32 s22, 231424
  buffer_load_dwordx4 v[240:243], v3, s[8:11], s22 offen sc1
  s_waitcnt vmcnt(0)
  s_bitcmp1_b32 s3, 13
  s_cbranch_scc0 Lpd_27
  s_mov_b32 s91, 0
Lpl_26:
  v_cmp_ne_u32 vcc, s15, v240
  v_cmp_ne_u32 s[88:89], s15, v241
  s_nop 0
  s_or_b64 vcc, vcc, s[88:89]
  v_cmp_ne_u32 s[88:89], s15, v242
  s_nop 0
  s_or_b64 vcc, vcc, s[88:89]
  v_cmp_ne_u32 s[88:89], s15, v243
  s_nop 0
  s_or_b64 vcc, vcc, s[88:89]
  s_add_u32 s91, s91, 1
  s_cmp_eq_u64 vcc, 0
  s_cbranch_scc1 Lpd_27
  s_sleep 32
  buffer_load_dwordx4 v[240:243], v3, s[8:11], s22 offen sc1
  s_waitcnt vmcnt(0)
  s_cmp_lt_u32 s91, 8192
  s_cbranch_scc1 Lpl_26
Lpd_27:
  s_mov_b32 s22, 232448
  buffer_load_dwordx4 v[240:243], v3, s[8:11], s22 offen sc1
  s_waitcnt vmcnt(0)
  s_bitcmp1_b32 s3, 13
  s_cbranch_scc0 Lpd_29
  s_mov_b32 s91, 0
Lpl_28:
  v_cmp_ne_u32 vcc, s15, v240
  v_cmp_ne_u32 s[88:89], s15, v241
  s_nop 0
  s_or_b64 vcc, vcc, s[88:89]
  v_cmp_ne_u32 s[88:89], s15, v242
  s_nop 0
  s_or_b64 vcc, vcc, s[88:89]
  v_cmp_ne_u32 s[88:89], s15, v243
  s_nop 0
  s_or_b64 vcc, vcc, s[88:89]
  s_add_u32 s91, s91, 1
  s_cmp_eq_u64 vcc, 0
  s_cbranch_scc1 Lpd_29
  s_sleep 32
  buffer_load_dwordx4 v[240:243], v3, s[8:11], s22 offen sc1
  s_waitcnt vmcnt(0)
  s_cmp_lt_u32 s91, 8192
  s_cbranch_scc1 Lpl_28
Lpd_29:
  s_mov_b32 s22, 81664
  buffer_load_dword v240, v5, s[8:11], s22 offen sc1
  s_waitcnt vmcnt(0)
  s_bitcmp1_b32 s3, 13
  s_cbranch_scc0 Lpd_31
  s_mov_b32 s91, 0
Lpl_30:
  v_cmp_ne_u32 vcc, s15, v240
  s_add_u32 s91, s91, 1
  s_cmp_eq_u64 vcc, 0
  s_cbranch_scc1 Lpd_31
  s_sleep 32
  buffer_load_dword v240, v5, s[8:11], s22 offen sc1
  s_waitcnt vmcnt(0)
  s_cmp_lt_u32 s91, 8192
  s_cbranch_scc1 Lpl_30
Lpd_31:
  v_mov_b32 v3, 49152
  v_mov_b32 v4, s15
  s_mov_b64 exec, 1
  buffer_store_dword v4, v3, s[8:11], 0 offen sc1
  s_endpgm
L_ln_g2:
  v_min_u32 v3, 53, v2
  v_lshlrev_b32 v3, 4, v3
  s_and_b32 s22, s2, 7
  s_bfe_u32 s88, s13, 0x20001
  s_lshl2_add_u32 s22, s22, s88
  s_lshl_b32 s22, s22, 10
  s_add_u32 s22, s22, 196608
  s_bfe_u32 s71, s13, 0x10002
  s_mul_i32 s71, s71, 7
  v_mov_b32 v63, 0
  s_mov_b32 s67, 0
  s_mov_b32 s64, 2
  s_cmp_lg_u32 s12, 0
  s_cbranch_scc1 L_ln_g2b
  buffer_load_dwordx4 v[240:243], v3, s[8:11], s22 offen
  s_waitcnt vmcnt(0)
  s_bitcmp1_b32 s3, 12
  s_cbranch_scc0 Lpd_33
  s_mov_b32 s91, 0
Lpl_32:
  v_cmp_ne_u32 vcc, s15, v240
  v_cmp_ne_u32 s[88:89], s15, v241
  s_nop 0
  s_or_b64 vcc, vcc, s[88:89]
  v_cmp_ne_u32 s[88:89], s15, v242
  s_nop 0
  s_or_b64 vcc, vcc, s[88:89]
  v_cmp_ne_u32 s[88:89], s15, v243
  s_nop 0
  s_or_b64 vcc, vcc, s[88:89]
  s_add_u32 s91, s91, 1
  s_cmp_eq_u64 vcc, 0
  s_cbranch_scc1 Lpd_33
  s_sleep 16
  buffer_load_dwordx4 v[240:243], v3, s[8:11], s22 offen sc1
  s_waitcnt vmcnt(0)
  s_cmp_lt_u32 s91, 16384
  s_cbranch_scc1 Lpl_32
Lpd_33:
L_ln_g2b:
  s_and_b32 s21, s13, 7
  s_lshl2_add_u32 s18, s71, s12
  s_mul_i32 s23, s21, 276480
  s_add_u32 s23, s23, 8388608
  s_add_u32 s36, s4, s23
  s_addc_u32 s37, s5, 0
  s_mov_b32 s38, 276480
  s_mov_b32 s39, 0x00020000
  v_lshlrev_b32 v4, 4, v2
  v_add_u32 v5, 4096, v4
  s_mul_i32 s33, s18, 5120
  s_mov_b32 s34, s33
  s_lshr_b32 s20, s13, 3
  s_lshl1_add_u32 s20, s14, s20
  s_lshl_b32 s32, s18, 12
  s_lshl_b32 s35, s12, 12
  s_mul_i32 s23, s20, 221184
  s_add_u32 s24, s4, s23
  s_addc_u32 s25, s5, 0
  s_mov_b32 s26, 221184
  s_mov_b32 s27, 0x00020000
  v_min_u32 v3, 13, v2
  v_add_u32 v3, s71, v3
  v_subrev_u32 v1, 14, v3
  v_min_u32 v3, v1, v3
  v_lshlrev_b32 v3, 2, v3
  s_lshl_b32 s22, s14, 4
  s_add_u32 s22, s22, s13
  s_lshl_b32 s22, s22, 8
  s_add_u32 s22, s22, 131072
  s_xor_b32 s23, s12, 0
  s_lshl_b32 s23, s23, 10
  v_add_u32 v6, s23, v4
  s_xor_b32 s23, s12, 1
  s_lshl_b32 s23, s23, 10
  v_add_u32 v7, s23, v4
  s_xor_b32 s23, s12, 2
  s_lshl_b32 s23, s23, 10
  v_add_u32 v8, s23, v4
  s_xor_b32 s23, s12, 3
  s_lshl_b32 s23, s23, 10
  v_add_u32 v9, s23, v4
  s_cmp_eq_u32 s64, 2
  s_cselect_b32 s66, 0, 1
  s_bitcmp1_b32 s3, 9
  s_cselect_b32 s66, s66, -1
  s_barrier
  s_branch L_g2wq
R_S:
  s_setprio 3
  s_load_dwordx8 s[56:63], s[0:1], 8
  s_load_dwordx8 s[64:71], s[0:1], 40
  s_and_b32 s18, s2, 7
  s_lshr_b32 s21, s18, 1
  s_mul_i32 s21, s21, 27
  s_add_u32 s21, s21, s19
  s_and_b32 s22, s21, 1
  s_lshr_b32 s21, s21, 1
  s_and_b32 s23, s18, 1
  s_lshl1_add_u32 s22, s23, s22
  s_mul_i32 s25, s19, 3
  s_mul_i32 s26, s18, 80
  s_add_u32 s25, s25, s26
  s_add_u32 s26, s25, s12
  v_lshlrev_b32 v9, 2, v2
  s_lshl_b32 s27, s26, 8
  s_lshl_b32 s28, s26, 1
  v_mov_b32 v10, s28
  s_mov_b32 s38, 163840
  s_mov_b32 s39, 0x00020000
  s_mov_b32 s42, 163840
  s_mov_b32 s43, 0x00020000
  s_waitcnt lgkmcnt(0)
  s_mov_b64 s[36:37], s[56:57]
  buffer_load_dword v16, v9, s[36:39], s27 offen
  s_mov_b64 s[40:41], s[58:59]
  buffer_load_dword v17, v9, s[40:43], s27 offen
  s_mov_b64 s[36:37], s[60:61]
  buffer_load_dword v18, v9, s[36:39], s27 offen
  s_mov_b64 s[40:41], s[62:63]
  buffer_load_dword v19, v9, s[40:43], s27 offen
  s_mov_b64 s[36:37], s[64:65]
  buffer_load_dword v20, v9, s[36:39], s27 offen
  s_mov_b64 s[40:41], s[66:67]
  buffer_load_dword v21, v9, s[40:43], s27 offen
  s_mov_b64 s[36:37], s[68:69]
  s_mov_b32 s38, 1280
  buffer_load_ushort v22, v10, s[36:39], 0 offen
  s_mov_b64 s[40:41], s[70:71]
  s_mov_b32 s42, 1280
  buffer_load_ushort v23, v10, s[40:43], 0 offen
  s_lshl_b32 s23, s21, 5
  s_lshl_b32 s24, s12, 3
  s_add_u32 s23, s23, s24
  s_mul_i32 s23, s23, 1280
  s_mul_i32 s24, s22, 320
  s_add_u32 s23, s23, s24
  s_mul_i32 s24, s12, 3072
  s_add_u32 s24, s24, 64064
  s_mov_b32 s32, s52
  s_mov_b32 s33, s53
  s_mov_b32 s34, 2211840
  s_mov_b32 s35, 0x00020000
  v_add_u32 v3, 0, v2
  v_mul_u32_u24 v4, 205, v3
  v_lshrrev_b32 v4, 12, v4
  v_mul_u32_u24 v4, 960, v4
  v_lshl_add_u32 v6, v3, 4, v4
  s_add_u32 m0, s24, 0
  s_nop 0
  buffer_load_dwordx4 v6, s[32:35], s23 offen lds
  v_add_u32 v3, 64, v2
  v_mul_u32_u24 v4, 205, v3
  v_lshrrev_b32 v4, 12, v4
  v_mul_u32_u24 v4, 960, v4
  v_lshl_add_u32 v6, v3, 4, v4
  s_add_u32 m0, s24, 1024
  s_nop 0
  buffer_load_dwordx4 v6, s[32:35], s23 offen lds
  v_add_u32 v3, 128, v2
  v_mul_u32_u24 v4, 205, v3
  v_lshrrev_b32 v4, 12, v4
  v_mul_u32_u24 v4, 960, v4
  v_lshl_add_u32 v6, v3, 4, v4
  s_add_u32 m0, s24, 2048
  s_mov_b32 exec_hi, 0
  buffer_load_dwordx4 v6, s[32:35], s23 offen lds
  s_mov_b32 exec_hi, -1
  s_setprio 0
  s_add_u32 s8, s4, 20971520
  s_addc_u32 s9, s5, 0
  s_mov_b32 s10, 262144
  s_mov_b32 s11, 0x00020000
  s_buffer_load_dword s15, s[8:11], 49152
  s_add_u32 s32, s4, 8388608
  s_addc_u32 s33, s5, 0
  s_mov_b32 s34, 2211840
  s_mov_b32 s35, 0x00020000
  s_add_u32 s40, s4, 12582912
  s_addc_u32 s41, s5, 0
  s_mov_b32 s42, 2621440
  s_mov_b32 s43, 0x00020000
  s_add_u32 s44, s4, 16777216
  s_addc_u32 s45, s5, 0
  s_mov_b32 s46, 2621440
  s_mov_b32 s47, 0x00020000
  v_mov_b32 v24, 0
  v_mov_b32 v25, 0
  v_mov_b32 v26, 0
  v_mov_b32 v27, 0
  v_lshrrev_b32 v3, 3, v2
  v_and_b32 v4, 7, v2
  v_mul_u32_u24 v5, 1344, v3
  v_lshl_add_u32 v5, v4, 4, v5
  s_mul_i32 s29, s12, 5376
  s_add_u32 s29, s29, 47936
  v_add_u32 v5, s29, v5
  s_mul_i32 s30, s12, 4160
  s_add_u32 s30, s30, 35456
  v_lshl_add_u32 v11, v2, 4, s30
  s_cmp_eq_u32 s12, 3
  s_cselect_b32 s88, 0, 0x7f7f7f7f
  s_cselect_b32 s90, 0, 0xf
  s_mov_b32 s89, 0
  s_mov_b32 s91, 0
  s_mov_b64 exec, s[88:89]
  ds_write_b128 v5, v[24:27]
  s_mov_b64 exec, s[90:91]
  ds_write_b128 v11, v[24:27]
  s_mov_b64 exec, -1
  v_lshrrev_b32 v3, 4, v2
  v_bfe_u32 v4, v2, 2, 2
  v_and_b32 v5, 3, v2
  v_and_b32 v11, 1, v3
  v_lshrrev_b32 v12, 1, v3
  v_lshl_add_u32 v11, v11, 2, v4
  v_mul_u32_u24 v11, 320, v11
  v_mul_u32_u24 v12, 6144, v12
  v_add_u32 v11, v11, v12
  v_lshl_add_u32 v11, v5, 3, v11
  s_lshl_b32 s29, s12, 5
  s_add_u32 s29, s29, 64064
  v_add_u32 v11, s29, v11
  v_lshlrev_b32 v12, 4, v2
  s_mul_i32 s48, s21, 5120
  s_mul_i32 s49, s22, 552960
  s_add_u32 s48, s48, s49
  s_lshl_b32 s49, s12, 10
  s_add_u32 s48, s48, s49
  s_add_u32 s49, s48, 4096
  s_add_u32 s50, s48, 275456
  s_cmp_eq_u32 s12, 0
  s_cselect_b32 s49, s49, s50
  s_add_u32 s50, s48, 279552
  s_cmp_lt_u32 s12, 2
  s_cselect_b32 s50, s50, 0x40000000
  s_lshl_b32 s51, s22, 6
  s_add_u32 s51, s51, s21
  s_lshl2_add_u32 s51, s51, s12
  s_lshl_b32 s51, s51, 2
  s_add_u32 s51, s51, 196608
  v_and_b32 v4, 15, v2
  v_lshlrev_b32 v5, 3, v4
  v_cvt_f32_u32 v80, v5
  v_and_b32 v5, 7, v4
  v_lshrrev_b32 v6, 3, v4
  v_lshl_add_u32 v5, v6, 7, v5
  v_cvt_f32_u32 v81, v5
  v_and_b32 v5, 1, v4
  v_bfe_u32 v7, v4, 1, 1
  v_lshl_add_u32 v5, v7, 6, v5
  v_add_u32 v5, 128, v5
  v_add_u32 v7, 1, v6
  v_lshlrev_b32 v5, v7, v5
  v_bfe_u32 v7, v4, 2, 1
  v_mul_u32_u24 v8, 5, v6
  v_add_u32 v8, 2, v8
  v_lshlrev_b32 v7, v8, v7
  v_add_u32 v5, v5, v7
  v_cvt_f32_u32 v82, v5
  v_and_b32 v5, 11, v4
  v_cmp_gt_u32 vcc, 8, v4
  s_nop 1
  v_cndmask_b32 v5, v5, v4, vcc
  v_lshlrev_b32 v5, 7, v5
  v_add_u32 v5, 1024, v5
  v_cvt_f32_u32 v83, v5
  v_and_b32 v5, 1, v3
  v_lshrrev_b32 v6, 1, v3
  v_lshlrev_b32 v84, 5, v4
  v_lshl_add_u32 v84, v5, 4, v84
  v_lshl_add_u32 v84, v6, 9, v84
  v_sub_u32 v7, 4, v6
  v_lshlrev_b32 v85, v7, v4
  v_lshlrev_b32 v7, 2, v6
  v_add_u32 v7, 3, v7
  v_lshlrev_b32 v7, v7, v5
  v_add_u32 v85, v85, v7
  v_lshl_add_u32 v85, v6, 10, v85
  v_add_u32 v85, 1536, v85
  v_mul_u32_u24 v7, v5, v6
  v_sub_u32 v7, v3, v7
  v_lshlrev_b32 v86, 8, v7
  v_lshl_add_u32 v86, v6, 9, v86
  v_lshl_add_u32 v86, v4, 2, v86
  v_add_u32 v86, 3584, v86
  s_lshr_b32 s56, s12, 1
  s_and_b32 s57, s12, 1
  s_lshl_b32 s58, s56, 11
  s_lshl_b32 s59, s56, 10
  s_add_u32 s59, s59, 4096
  s_add_u32 s61, s58, 768
  s_sub_u32 s61, s61, s59
  s_cmp_eq_u32 s57, 0
  s_cselect_b32 s58, s58, s59
  s_cselect_b32 s61, 256, s61
  s_add_u32 s58, s58, 29312
  s_add_u32 s60, s56, 4
  s_mul_i32 s60, s60, 4880
  s_mul_i32 s63, s12, 4880
  v_lshl_add_u32 v87, v3, 6, s58
  s_mov_b32 s64, 0xffff0000
  s_mov_b32 s66, 0x3fb8aa3b
  s_mov_b32 s67, 0x3e22f983
  s_setprio 3
  s_waitcnt vmcnt(3)
  v_lshlrev_b32 v22, 16, v22
  v_mul_f32 v22, s66, v22
  v_exp_f32 v22, v22
  s_nop 0
  v_cvt_pk_bf16_f32 v22, v22, v22
  v_lshlrev_b32 v22, 16, v22
  v_lshlrev_b32 v23, 16, v23
  v_lshlrev_b32 v48, 16, v16
  v_and_b32 v64, s64, v16
  v_lshlrev_b32 v49, 16, v17
  v_and_b32 v65, s64, v17
  v_lshlrev_b32 v50, 16, v18
  v_and_b32 v66, s64, v18
  v_lshlrev_b32 v51, 16, v19
  v_and_b32 v67, s64, v19
  v_lshlrev_b32 v52, 16, v20
  v_and_b32 v68, s64, v20
  v_lshlrev_b32 v53, 16, v21
  v_and_b32 v69, s64, v21
  v_pk_mul_f32 v[48:49], v[48:49], v[22:23] op_sel_hi:[1,0]
  v_pk_mul_f32 v[64:65], v[64:65], v[22:23] op_sel_hi:[1,0]
  v_pk_mul_f32 v[40:41], v[48:49], s[66:67]
  v_pk_mul_f32 v[44:45], v[64:65], s[66:67]
  v_pk_mul_f32 v[50:51], v[50:51], v[22:23] op_sel_hi:[1,0]
  v_pk_mul_f32 v[66:67], v[66:67], v[22:23] op_sel_hi:[1,0]
  v_pk_mul_f32 v[54:55], v[52:53], v[50:51] op_sel_hi:[1,0]
  v_pk_mul_f32 v[70:71], v[68:69], v[66:67] op_sel_hi:[1,0]
  v_pk_fma_f32 v[42:43], v[52:53], v[50:51], v[54:55] op_sel:[1,1,0] op_sel_hi:[0,1,1] neg_lo:[1,0,0]
  v_pk_fma_f32 v[46:47], v[68:69], v[66:67], v[70:71] op_sel:[1,1,0] op_sel_hi:[0,1,1] neg_lo:[1,0,0]
  s_lshl_b32 s29, s12, 11
  s_add_u32 s29, s29, 29312
  v_lshl_add_u32 v3, v2, 5, s29
  s_mul_i32 s29, s12, 9760
  v_mov_b32 v4, s29
  s_cmp_eq_u32 s12, 3
  s_cselect_b64 exec, 0, -1
  ds_write_b128 v3, v[40:43]
  ds_write_b128 v3, v[44:47] offset:16
  ds_write_b32 v4, v23 offset:4864
  s_mov_b64 exec, -1
  v_mov_b32 v16, 0
  v_mov_b32 v17, 0
  v_mov_b32 v18, 0
  v_mov_b32 v19, 0
  v_mov_b32 v20, 0
  v_mov_b32 v21, 0
  v_mov_b32 v22, 0
  v_mov_b32 v23, 0
  v_mov_b32 v24, 0
  v_mov_b32 v25, 0
  v_mov_b32 v26, 0
  v_mov_b32 v27, 0
  s_mov_b32 s59, 0
  s_waitcnt vmcnt(0) lgkmcnt(0)
  s_barrier
  ds_read_b64_tr_b16 v[96:97], v11 offset:0
  ds_read_b64_tr_b16 v[98:99], v11 offset:3072
  ds_read_b64_tr_b16 v[100:101], v11 offset:128
  ds_read_b64_tr_b16 v[102:103], v11 offset:3200
  ds_read_b64_tr_b16 v[104:105], v11 offset:256
  ds_read_b64_tr_b16 v[106:107], v11 offset:3328
  ds_read_b128 v[32:35], v87 offset:0
  ds_read_b128 v[36:39], v87 offset:16
  ds_read_b128 v[40:43], v87 offset:32
  ds_read_b128 v[44:47], v87 offset:48
  s_waitcnt lgkmcnt(4)
  buffer_store_dwordx4 v[96:99], v12, s[32:35], s48 offen sc1
  buffer_store_dwordx4 v[100:103], v12, s[32:35], s49 offen sc1
  buffer_store_dwordx4 v[104:107], v12, s[32:35], s50 offen sc1
  s_add_u32 s15, s15, 1
  v_lshlrev_b32 v4, 12, v2
  v_mov_b32 v5, s15
  s_waitcnt vmcnt(0)
  s_mov_b64 exec, 0x1ff
  buffer_store_dword v5, v4, s[8:11], s51 offen sc1
  s_mov_b64 exec, -1
  s_setprio 0
.p2align 6
L_s_chunk:
  s_cmp_eq_u32 s59, 3
  s_cselect_b32 s62, s61, 256
  s_waitcnt lgkmcnt(0)
  v_mul_f32 v125, v33, v80
  v_mul_f32 v141, v37, v80
  v_mul_f32 v157, v41, v80
  v_mul_f32 v173, v45, v80
  v_mul_f32 v124, v32, v80
  v_mul_f32 v140, v36, v80
  v_mul_f32 v156, v40, v80
  v_mul_f32 v172, v44, v80
  v_fract_f32 v125, v125
  v_fract_f32 v141, v141
  v_fract_f32 v157, v157
  v_fract_f32 v173, v173
  v_exp_f32 v124, v124
  v_exp_f32 v140, v140
  v_exp_f32 v156, v156
  v_exp_f32 v172, v172
  v_cos_f32 v126, v125
  v_cos_f32 v142, v141
  v_cos_f32 v158, v157
  v_cos_f32 v174, v173
  v_sin_f32 v127, v125
  v_sin_f32 v143, v141
  v_sin_f32 v159, v157
  v_sin_f32 v175, v173
  v_mul_f32 v125, v35, v124
  v_mul_f32 v141, v39, v140
  v_mul_f32 v157, v43, v156
  v_mul_f32 v173, v47, v172
  v_mul_f32 v124, v34, v124
  v_mul_f32 v140, v38, v140
  v_mul_f32 v156, v42, v156
  v_mul_f32 v172, v46, v172
  v_mul_f32 v64, v125, v127
  v_mul_f32 v66, v141, v143
  v_mul_f32 v68, v157, v159
  v_mul_f32 v70, v173, v175
  v_mul_f32 v65, v125, v126
  v_mul_f32 v67, v141, v142
  v_mul_f32 v69, v157, v158
  v_mul_f32 v71, v173, v174
  v_fma_f32 v64, v124, v126, -v64
  v_fma_f32 v66, v140, v142, -v66
  v_fma_f32 v68, v156, v158, -v68
  v_fma_f32 v70, v172, v174, -v70
  v_fma_f32 v65, -v124, v127, -v65
  v_fma_f32 v67, -v140, v143, -v67
  v_fma_f32 v69, -v156, v159, -v69
  v_fma_f32 v71, -v172, v175, -v71
  v_cvt_pk_bf16_f32 v60, v64, v65
  v_cvt_pk_bf16_f32 v61, v66, v67
  v_cvt_pk_bf16_f32 v62, v68, v69
  v_cvt_pk_bf16_f32 v63, v70, v71
  v_mul_f32 v113, v33, v81
  v_mul_f32 v129, v37, v81
  v_mul_f32 v145, v41, v81
  v_mul_f32 v161, v45, v81
  v_mul_f32 v112, v32, v81
  v_mul_f32 v128, v36, v81
  v_mul_f32 v144, v40, v81
  v_mul_f32 v160, v44, v81
  v_mul_f32 v117, v33, v82
  v_mul_f32 v133, v37, v82
  v_mul_f32 v149, v41, v82
  v_mul_f32 v165, v45, v82
  v_mul_f32 v116, v32, v82
  v_mul_f32 v132, v36, v82
  v_mul_f32 v148, v40, v82
  v_mul_f32 v164, v44, v82
  v_mul_f32 v121, v33, v83
  v_mul_f32 v137, v37, v83
  v_mul_f32 v153, v41, v83
  v_mul_f32 v169, v45, v83
  v_mul_f32 v120, v32, v83
  v_mul_f32 v136, v36, v83
  v_mul_f32 v152, v40, v83
  v_mul_f32 v168, v44, v83
  v_add_u32 v87, s62, v87
  ds_read_b128 v[32:35], v87 offset:0
  ds_read_b128 v[36:39], v87 offset:16
  ds_read_b128 v[40:43], v87 offset:32
  ds_read_b128 v[44:47], v87 offset:48
  v_fract_f32 v113, v113
  v_fract_f32 v129, v129
  v_fract_f32 v145, v145
  v_fract_f32 v161, v161
  v_exp_f32 v112, v112
  v_exp_f32 v128, v128
  v_exp_f32 v144, v144
  v_exp_f32 v160, v160
  v_cos_f32 v114, v113
  v_cos_f32 v130, v129
  v_cos_f32 v146, v145
  v_cos_f32 v162, v161
  v_sin_f32 v115, v113
  v_sin_f32 v131, v129
  v_sin_f32 v147, v145
  v_sin_f32 v163, v161
  v_mul_f32 v114, v114, v112
  v_mul_f32 v130, v130, v128
  v_mul_f32 v146, v146, v144
  v_mul_f32 v162, v162, v160
  v_mul_f32 v115, v115, v112
  v_mul_f32 v131, v131, v128
  v_mul_f32 v147, v147, v144
  v_mul_f32 v163, v163, v160
  v_cvt_pk_bf16_f32 v48, v114, v115
  v_cvt_pk_bf16_f32 v49, v130, v131
  v_cvt_pk_bf16_f32 v50, v146, v147
  v_cvt_pk_bf16_f32 v51, v162, v163
  s_nop 1
  v_mfma_f32_16x16x32_bf16 v[16:19], v[48:51], v[60:63], v[16:19]
  v_fract_f32 v117, v117
  v_fract_f32 v133, v133
  v_fract_f32 v149, v149
  v_fract_f32 v165, v165
  v_exp_f32 v116, v116
  v_exp_f32 v132, v132
  v_exp_f32 v148, v148
  v_exp_f32 v164, v164
  v_cos_f32 v118, v117
  v_cos_f32 v134, v133
  v_cos_f32 v150, v149
  v_cos_f32 v166, v165
  v_sin_f32 v119, v117
  v_sin_f32 v135, v133
  v_sin_f32 v151, v149
  v_sin_f32 v167, v165
  v_mul_f32 v118, v118, v116
  v_mul_f32 v134, v134, v132
  v_mul_f32 v150, v150, v148
  v_mul_f32 v166, v166, v164
  v_mul_f32 v119, v119, v116
  v_mul_f32 v135, v135, v132
  v_mul_f32 v151, v151, v148
  v_mul_f32 v167, v167, v164
  v_cvt_pk_bf16_f32 v52, v118, v119
  v_cvt_pk_bf16_f32 v53, v134, v135
  v_cvt_pk_bf16_f32 v54, v150, v151
  v_cvt_pk_bf16_f32 v55, v166, v167
  s_nop 1
  v_mfma_f32_16x16x32_bf16 v[20:23], v[52:55], v[60:63], v[20:23]
  v_fract_f32 v121, v121
  v_fract_f32 v137, v137
  v_fract_f32 v153, v153
  v_fract_f32 v169, v169
  v_exp_f32 v120, v120
  v_exp_f32 v136, v136
  v_exp_f32 v152, v152
  v_exp_f32 v168, v168
  v_cos_f32 v122, v121
  v_cos_f32 v138, v137
  v_cos_f32 v154, v153
  v_cos_f32 v170, v169
  v_sin_f32 v123, v121
  v_sin_f32 v139, v137
  v_sin_f32 v155, v153
  v_sin_f32 v171, v169
  v_mul_f32 v122, v122, v120
  v_mul_f32 v138, v138, v136
  v_mul_f32 v154, v154, v152
  v_mul_f32 v170, v170, v168
  v_mul_f32 v123, v123, v120
  v_mul_f32 v139, v139, v136
  v_mul_f32 v155, v155, v152
  v_mul_f32 v171, v171, v168
  v_cvt_pk_bf16_f32 v56, v122, v123
  v_cvt_pk_bf16_f32 v57, v138, v139
  v_cvt_pk_bf16_f32 v58, v154, v155
  v_cvt_pk_bf16_f32 v59, v170, v171
  s_add_u32 s59, s59, 1
  s_cmp_lt_u32 s59, 4
  v_mfma_f32_16x16x32_bf16 v[24:27], v[56:59], v[60:63], v[24:27]
  s_cbranch_scc1 L_s_side
  s_cmp_eq_u32 s59, 5
  s_cbranch_scc1 L_s_p2
  s_cmp_eq_u32 s59, 6
  s_cselect_b32 s60, s63, s60
  s_cselect_b32 s57, 1, s57
  s_cmp_eq_u32 s57, 0
  s_cbranch_scc1 L_s_nofl
  v_add_u32 v4, s60, v84
  v_add_u32 v5, s60, v85
  v_add_u32 v6, s60, v86
  s_nop 7
  ds_write_b128 v4, v[16:19] offset:0
  ds_write2_b64 v5, v[20:21], v[22:23] offset0:0 offset1:32
  ds_write2_b32 v6, v24, v25 offset0:0 offset1:16
  ds_write2_b32 v6, v26, v27 offset0:32 offset1:48
  s_cmp_eq_u32 s59, 6
  s_cbranch_scc1 L_s_kdone
  v_mov_b32 v16, 0
  v_mov_b32 v17, 0
  v_mov_b32 v18, 0
  v_mov_b32 v19, 0
  v_mov_b32 v20, 0
  v_mov_b32 v21, 0
  v_mov_b32 v22, 0
  v_mov_b32 v23, 0
  v_mov_b32 v24, 0
  v_mov_b32 v25, 0
  v_mov_b32 v26, 0
  v_mov_b32 v27, 0
L_s_nofl:
  v_lshlrev_b32 v3, 2, v2
  s_and_b32 s56, s2, 63
  s_lshl_b32 s56, s56, 8
  s_add_u32 s56, s56, 65536
  s_cmp_lg_u32 s12, 0
  s_cbranch_scc1 L_s_chunk
  buffer_load_dword v240, v3, s[8:11], s56 offen
  s_branch L_s_chunk
L_s_side:
  s_cmp_lg_u32 s59, 9
  s_cbranch_scc1 L_s_chunk
  v_lshlrev_b32 v4, 12, v2
  v_mov_b32 v5, s15
  s_waitcnt vmcnt(0)
  s_mov_b64 exec, 0x1ff
  buffer_store_dword v5, v4, s[8:11], s51 offen sc1
  s_mov_b64 exec, -1
  s_setprio 0
  s_branch L_s_chunk
L_s_p2:
  v_mul_u32_u24 v5, 40960, v2
  s_mul_i32 s57, s12, 10240
  s_lshl_b32 s58, s25, 4
  s_add_u32 s57, s57, s58
  s_mul_i32 s58, s12, 1344
  s_add_u32 s58, s58, 48048
  s_waitcnt vmcnt(0)
  s_cmp_lg_u32 s12, 0
  s_cbranch_scc1 L_s_xw
  s_bitcmp1_b32 s3, 10
  s_cbranch_scc0 Lpd_35
  s_mov_b32 s91, 0
Lpl_34:
  v_cmp_ne_u32 vcc, s15, v240
  s_add_u32 s91, s91, 1
  s_cmp_eq_u64 vcc, 0
  s_cbranch_scc1 Lpd_35
  s_sleep 8
  buffer_load_dword v240, v3, s[8:11], s56 offen sc1
  s_waitcnt vmcnt(0)
  s_cmp_lt_u32 s91, 32768
  s_cbranch_scc1 Lpl_34
Lpd_35:
L_s_xw:
  s_barrier
  s_add_u32 m0, s58, 0
  s_nop 0
  buffer_load_dwordx4 v5, s[40:43], s57 offen  lds
  s_add_u32 s57, s57, 16
  s_add_u32 m0, s58, 5376
  s_nop 0
  buffer_load_dwordx4 v5, s[40:43], s57 offen  lds
  s_add_u32 s57, s57, 16
  s_add_u32 m0, s58, 10752
  s_nop 0
  buffer_load_dwordx4 v5, s[40:43], s57 offen  lds
  s_add_u32 s57, s57, 16
  s_branch L_s_chunk
L_s_kdone:
  s_setprio 2
  v_lshlrev_b32 v6, 1, v0
  s_movk_i32 s59, 0xff
  s_mov_b32 s60, 0xffffff80
  v_add_u32 v7, 0, v6
  v_cvt_f32_u32 v8, v7
  v_cvt_pk_bf16_f32 v8, v8, v8
  v_and_b32 v8, 0xffff, v8
  v_and_b32 v9, s60, v8
  v_add_u32 v9, v9, v8
  v_subrev_u32 v9, 34176, v9
  v_cmp_ge_u32 vcc, s59, v7
  s_nop 1
  v_cndmask_b32 v9, v9, v7, vcc
  v_lshlrev_b32 v80, 2, v9
  v_add_u32 v7, 1, v6
  v_cvt_f32_u32 v8, v7
  v_cvt_pk_bf16_f32 v8, v8, v8
  v_and_b32 v8, 0xffff, v8
  v_and_b32 v9, s60, v8
  v_add_u32 v9, v9, v8
  v_subrev_u32 v9, 34176, v9
  v_cmp_ge_u32 vcc, s59, v7
  s_nop 1
  v_cndmask_b32 v9, v9, v7, vcc
  v_lshlrev_b32 v81, 2, v9
  v_add_u32 v7, 512, v6
  v_cvt_f32_u32 v8, v7
  v_cvt_pk_bf16_f32 v8, v8, v8
  v_and_b32 v8, 0xffff, v8
  v_and_b32 v9, s60, v8
  v_add_u32 v9, v9, v8
  v_subrev_u32 v9, 34176, v9
  v_lshlrev_b32 v82, 2, v9
  v_add_u32 v7, 513, v6
  v_cvt_f32_u32 v8, v7
  v_cvt_pk_bf16_f32 v8, v8, v8
  v_and_b32 v8, 0xffff, v8
  v_and_b32 v9, s60, v8
  v_add_u32 v9, v9, v8
  v_subrev_u32 v9, 34176, v9
  v_lshlrev_b32 v83, 2, v9
  v_add_u32 v7, 1024, v6
  v_cvt_f32_u32 v8, v7
  v_cvt_pk_bf16_f32 v8, v8, v8
  v_and_b32 v8, 0xffff, v8
  v_and_b32 v9, s60, v8
  v_add_u32 v9, v9, v8
  v_subrev_u32 v9, 34176, v9
  v_lshlrev_b32 v84, 2, v9
  v_add_u32 v7, 1025, v6
  v_cvt_f32_u32 v8, v7
  v_cvt_pk_bf16_f32 v8, v8, v8
  v_and_b32 v8, 0xffff, v8
  v_and_b32 v9, s60, v8
  v_add_u32 v9, v9, v8
  v_subrev_u32 v9, 34176, v9
  v_lshlrev_b32 v85, 2, v9
  v_add_u32 v7, 1536, v6
  v_cvt_f32_u32 v8, v7
  v_cvt_pk_bf16_f32 v8, v8, v8
  v_and_b32 v8, 0xffff, v8
  v_and_b32 v9, s60, v8
  v_add_u32 v9, v9, v8
  v_subrev_u32 v9, 34176, v9
  v_lshlrev_b32 v86, 2, v9
  v_add_u32 v7, 1537, v6
  v_cvt_f32_u32 v8, v7
  v_cvt_pk_bf16_f32 v8, v8, v8
  v_and_b32 v8, 0xffff, v8
  v_and_b32 v9, s60, v8
  v_add_u32 v9, v9, v8
  v_subrev_u32 v9, 34176, v9
  v_lshlrev_b32 v87, 2, v9
  v_lshlrev_b32 v10, 2, v0
  v_add_u32 v10, 35520, v10
  s_waitcnt lgkmcnt(0)
  s_barrier
  ds_read_b32 v16, v80 offset:0
  ds_read_b32 v24, v80 offset:4880
  ds_read_b32 v17, v81 offset:0
  ds_read_b32 v25, v81 offset:4880
  ds_read_b32 v18, v82 offset:0
  ds_read_b32 v26, v82 offset:4880
  ds_read_b32 v19, v83 offset:0
  ds_read_b32 v27, v83 offset:4880
  ds_read_b32 v20, v84 offset:0
  ds_read_b32 v28, v84 offset:4880
  ds_read_b32 v21, v85 offset:0
  ds_read_b32 v29, v85 offset:4880
  ds_read_b32 v22, v86 offset:0
  ds_read_b32 v30, v86 offset:4880
  ds_read_b32 v23, v87 offset:0
  ds_read_b32 v31, v87 offset:4880
  ds_read_b32 v32, v80 offset:9760
  ds_read_b32 v40, v80 offset:14640
  ds_read_b32 v33, v81 offset:9760
  ds_read_b32 v41, v81 offset:14640
  ds_read_b32 v34, v82 offset:9760
  ds_read_b32 v42, v82 offset:14640
  ds_read_b32 v35, v83 offset:9760
  ds_read_b32 v43, v83 offset:14640
  ds_read_b32 v36, v84 offset:9760
  ds_read_b32 v44, v84 offset:14640
  ds_read_b32 v37, v85 offset:9760
  ds_read_b32 v45, v85 offset:14640
  ds_read_b32 v38, v86 offset:9760
  ds_read_b32 v46, v86 offset:14640
  ds_read_b32 v39, v87 offset:9760
  ds_read_b32 v47, v87 offset:14640
  ds_read_b32 v48, v80 offset:19520
  ds_read_b32 v56, v80 offset:24400
  ds_read_b32 v49, v81 offset:19520
  ds_read_b32 v57, v81 offset:24400
  ds_read_b32 v50, v82 offset:19520
  ds_read_b32 v58, v82 offset:24400
  ds_read_b32 v51, v83 offset:19520
  ds_read_b32 v59, v83 offset:24400
  ds_read_b32 v52, v84 offset:19520
  ds_read_b32 v60, v84 offset:24400
  ds_read_b32 v53, v85 offset:19520
  ds_read_b32 v61, v85 offset:24400
  ds_read_b32 v54, v86 offset:19520
  ds_read_b32 v62, v86 offset:24400
  ds_read_b32 v55, v87 offset:19520
  ds_read_b32 v63, v87 offset:24400
  v_mov_b32 v7, 0
  ds_read_b32 v64, v7 offset:4864
  ds_read_b32 v65, v7 offset:14624
  ds_read_b32 v66, v7 offset:24384
  v_cmp_eq_u32 vcc, 0, v0
  s_waitcnt lgkmcnt(0)
  s_nop 0
  v_cndmask_b32 v64, 0, v64, vcc
  v_add_f32 v16, v16, v64
  v_pk_add_f32 v[16:17], v[16:17], v[24:25]
  v_pk_add_f32 v[18:19], v[18:19], v[26:27]
  v_pk_add_f32 v[20:21], v[20:21], v[28:29]
  v_pk_add_f32 v[22:23], v[22:23], v[30:31]
  v_cvt_pk_bf16_f32 v68, v16, v17
  ds_write_b32 v10, v68 offset:0
  v_cvt_pk_bf16_f32 v69, v18, v19
  ds_write_b32 v10, v69 offset:1024
  v_cvt_pk_bf16_f32 v70, v20, v21
  ds_write_b32 v10, v70 offset:2048
  v_cvt_pk_bf16_f32 v71, v22, v23
  ds_write_b32 v10, v71 offset:3072
  v_cndmask_b32 v65, 0, v65, vcc
  v_add_f32 v32, v32, v65
  v_pk_add_f32 v[32:33], v[32:33], v[40:41]
  v_pk_add_f32 v[34:35], v[34:35], v[42:43]
  v_pk_add_f32 v[36:37], v[36:37], v[44:45]
  v_pk_add_f32 v[38:39], v[38:39], v[46:47]
  v_cvt_pk_bf16_f32 v68, v32, v33
  ds_write_b32 v10, v68 offset:4160
  v_cvt_pk_bf16_f32 v69, v34, v35
  ds_write_b32 v10, v69 offset:5184
  v_cvt_pk_bf16_f32 v70, v36, v37
  ds_write_b32 v10, v70 offset:6208
  v_cvt_pk_bf16_f32 v71, v38, v39
  ds_write_b32 v10, v71 offset:7232
  v_cndmask_b32 v66, 0, v66, vcc
  v_add_f32 v48, v48, v66
  v_pk_add_f32 v[48:49], v[48:49], v[56:57]
  v_pk_add_f32 v[50:51], v[50:51], v[58:59]
  v_pk_add_f32 v[52:53], v[52:53], v[60:61]
  v_pk_add_f32 v[54:55], v[54:55], v[62:63]
  v_cvt_pk_bf16_f32 v68, v48, v49
  ds_write_b32 v10, v68 offset:8320
  v_cvt_pk_bf16_f32 v69, v50, v51
  ds_write_b32 v10, v69 offset:9344
  v_cvt_pk_bf16_f32 v70, v52, v53
  ds_write_b32 v10, v70 offset:10368
  v_cvt_pk_bf16_f32 v71, v54, v55
  ds_write_b32 v10, v71 offset:11392
  v_and_b32 v3, 1, v2
  v_lshlrev_b32 v3, 5, v3
  v_bfe_u32 v4, v2, 4, 1
  v_lshl_add_u32 v3, v4, 4, v3
  v_bfe_u32 v4, v2, 1, 1
  v_lshl_add_u32 v3, v4, 3, v3
  v_lshrrev_b32 v4, 5, v2
  v_lshlrev_b32 v5, 6, v4
  v_sub_u32 v3, v3, v5
  v_bfe_u32 v5, v2, 2, 2
  v_lshlrev_b32 v5, 3, v5
  v_sub_u32 v3, v3, v5
  v_add_u32 v3, 35552, v3
  v_and_b32 v5, 3, v2
  v_mul_u32_u24 v5, 1344, v5
  v_bfe_u32 v6, v2, 2, 3
  v_add_u32 v6, v6, v4
  v_lshl_add_u32 v5, v6, 4, v5
  v_add_u32 v5, 48032, v5
  v_bfe_u32 v6, v2, 2, 3
  v_lshl_add_u32 v6, v6, 1, v4
  v_lshlrev_b32 v7, 5, v6
  v_lshlrev_b32 v8, 4, v6
  v_add_u32 v8, 16400, v8
  v_add_u32 v7, 4096, v7
  s_mov_b32 s62, 0x11111111
  s_mov_b32 s63, 0x11111111
  s_waitcnt vmcnt(0) lgkmcnt(0)
  s_barrier
  s_cmp_eq_u32 s12, 3
  s_cbranch_scc1 L_s_w3
  s_mul_i32 s56, s12, 2080
  v_mov_b32 v9, s56
  v_mov_b32 v16, 0
  v_mov_b32 v17, 0
  v_mov_b32 v18, 0
  v_mov_b32 v19, 0
  s_mov_b64 exec, 1
  ds_write_b128 v9, v[16:19] offset:16384
  s_mov_b64 exec, -1
  s_mul_i32 s57, s12, 4160
  v_add_u32 v11, s57, v3
  s_mul_i32 s57, s12, 5376
  v_add_u32 v12, s57, v5
  s_lshl_b32 s57, s12, 12
  v_add_u32 v13, s57, v7
  v_add_u32 v14, s56, v8
  ds_read_b64_tr_b16 v[16:17], v11 offset:32
  ds_read_b64_tr_b16 v[18:19], v11 offset:0
  ds_read_b128 v[76:79], v12 offset:896
  ds_read_b128 v[72:75], v12 offset:768
  ds_read_b128 v[68:71], v12 offset:640
  ds_read_b128 v[64:67], v12 offset:512
  ds_read_b128 v[48:51], v12 offset:0
  ds_read_b64_tr_b16 v[20:21], v11 offset:544
  ds_read_b64_tr_b16 v[22:23], v11 offset:512
  ds_read_b128 v[60:63], v12 offset:384
  ds_read_b64_tr_b16 v[24:25], v11 offset:1056
  ds_read_b64_tr_b16 v[26:27], v11 offset:1024
  ds_read_b128 v[56:59], v12 offset:256
  ds_read_b64_tr_b16 v[28:29], v11 offset:1568
  ds_read_b64_tr_b16 v[30:31], v11 offset:1536
  ds_read_b128 v[52:55], v12 offset:128
  ds_read_b64_tr_b16 v[32:33], v11 offset:2080
  ds_read_b64_tr_b16 v[34:35], v11 offset:2048
  ds_read_b64_tr_b16 v[36:37], v11 offset:2592
  ds_read_b64_tr_b16 v[38:39], v11 offset:2560
  ds_read_b64_tr_b16 v[40:41], v11 offset:3104
  ds_read_b64_tr_b16 v[42:43], v11 offset:3072
  ds_read_b64_tr_b16 v[44:45], v11 offset:3616
  ds_read_b64_tr_b16 v[46:47], v11 offset:3584
  v_mov_b32 v96, 0
  v_mov_b32 v97, 0
  v_mov_b32 v98, 0
  v_mov_b32 v99, 0
  v_mov_b32 v100, 0
  v_mov_b32 v101, 0
  v_mov_b32 v102, 0
  v_mov_b32 v103, 0
  v_mov_b32 v104, 0
  v_mov_b32 v105, 0
  v_mov_b32 v106, 0
  v_mov_b32 v107, 0
  v_mov_b32 v108, 0
  v_mov_b32 v109, 0
  v_mov_b32 v110, 0
  v_mov_b32 v111, 0
  v_mov_b32 v112, 0
  v_mov_b32 v113, 0
  v_mov_b32 v114, 0
  v_mov_b32 v115, 0
  v_mov_b32 v116, 0
  v_mov_b32 v117, 0
  v_mov_b32 v118, 0
  v_mov_b32 v119, 0
  v_mov_b32 v120, 0
  v_mov_b32 v121, 0
  v_mov_b32 v122, 0
  v_mov_b32 v123, 0
  v_mov_b32 v124, 0
  v_mov_b32 v125, 0
  v_mov_b32 v126, 0
  v_mov_b32 v127, 0
  v_mov_b32 v128, 0
  v_mov_b32 v129, 0
  v_mov_b32 v130, 0
  v_mov_b32 v131, 0
  v_mov_b32 v132, 0
  v_mov_b32 v133, 0
  v_mov_b32 v134, 0
  v_mov_b32 v135, 0
  v_mov_b32 v136, 0
  v_mov_b32 v137, 0
  v_mov_b32 v138, 0
  v_mov_b32 v139, 0
  v_mov_b32 v140, 0
  v_mov_b32 v141, 0
  v_mov_b32 v142, 0
  v_mov_b32 v143, 0
  v_mov_b32 v144, 0
  v_mov_b32 v145, 0
  v_mov_b32 v146, 0
  v_mov_b32 v147, 0
  v_mov_b32 v148, 0
  v_mov_b32 v149, 0
  v_mov_b32 v150, 0
  v_mov_b32 v151, 0
  v_mov_b32 v152, 0
  v_mov_b32 v153, 0
  v_mov_b32 v154, 0
  v_mov_b32 v155, 0
  v_mov_b32 v156, 0
  v_mov_b32 v157, 0
  v_mov_b32 v158, 0
  v_mov_b32 v159, 0
  v_mov_b32 v160, 0
  v_mov_b32 v161, 0
  v_mov_b32 v162, 0
  v_mov_b32 v163, 0
  v_mov_b32 v164, 0
  v_mov_b32 v165, 0
  v_mov_b32 v166, 0
  v_mov_b32 v167, 0
  v_mov_b32 v168, 0
  v_mov_b32 v169, 0
  v_mov_b32 v170, 0
  v_mov_b32 v171, 0
  v_mov_b32 v172, 0
  v_mov_b32 v173, 0
  v_mov_b32 v174, 0
  v_mov_b32 v175, 0
  v_mov_b32 v176, 0
  v_mov_b32 v177, 0
  v_mov_b32 v178, 0
  v_mov_b32 v179, 0
  v_mov_b32 v180, 0
  v_mov_b32 v181, 0
  v_mov_b32 v182, 0
  v_mov_b32 v183, 0
  v_mov_b32 v184, 0
  v_mov_b32 v185, 0
  v_mov_b32 v186, 0
  v_mov_b32 v187, 0
  v_mov_b32 v188, 0
  v_mov_b32 v189, 0
  v_mov_b32 v190, 0
  v_mov_b32 v191, 0
  s_mov_b32 s56, 0
  s_waitcnt lgkmcnt(0)
  v_add_u32 v11, 128, v11
  v_subrev_u32 v12, 32, v12
.p2align 6
L_s_conv:
  s_waitcnt lgkmcnt(12)
  v_mfma_f32_32x32x16_bf16 v[176:191], v[16:19], v[76:79], v[176:191]
  v_mfma_f32_32x32x16_bf16 v[160:175], v[16:19], v[72:75], v[160:175]
  v_mfma_f32_32x32x16_bf16 v[144:159], v[16:19], v[68:71], v[144:159]
  v_mfma_f32_32x32x16_bf16 v[128:143], v[16:19], v[64:67], v[128:143]
  s_waitcnt lgkmcnt(0)
  v_mfma_f32_32x32x16_bf16 v[112:127], v[16:19], v[52:55], v[112:127]
  v_mfma_f32_32x32x16_bf16 v[96:111], v[16:19], v[48:51], v[96:111]
  ds_read_b64_tr_b16 v[16:17], v11 offset:32
  ds_read_b64_tr_b16 v[18:19], v11 offset:0
  ds_read_b128 v[76:79], v12 offset:896
  v_mfma_f32_32x32x16_bf16 v[176:191], v[20:23], v[72:75], v[176:191]
  v_mfma_f32_32x32x16_bf16 v[160:175], v[20:23], v[68:71], v[160:175]
  v_mfma_f32_32x32x16_bf16 v[144:159], v[20:23], v[64:67], v[144:159]
  v_mfma_f32_32x32x16_bf16 v[128:143], v[20:23], v[60:63], v[128:143]
  v_mfma_f32_32x32x16_bf16 v[112:127], v[20:23], v[48:51], v[112:127]
  ds_read_b64_tr_b16 v[20:21], v11 offset:544
  ds_read_b64_tr_b16 v[22:23], v11 offset:512
  ds_read_b128 v[72:75], v12 offset:768
  v_mfma_f32_32x32x16_bf16 v[176:191], v[24:27], v[68:71], v[176:191]
  v_mfma_f32_32x32x16_bf16 v[160:175], v[24:27], v[64:67], v[160:175]
  v_mfma_f32_32x32x16_bf16 v[144:159], v[24:27], v[60:63], v[144:159]
  v_mfma_f32_32x32x16_bf16 v[128:143], v[24:27], v[56:59], v[128:143]
  ds_read_b64_tr_b16 v[24:25], v11 offset:1056
  ds_read_b64_tr_b16 v[26:27], v11 offset:1024
  ds_read_b128 v[68:71], v12 offset:640
  v_mfma_f32_32x32x16_bf16 v[176:191], v[28:31], v[64:67], v[176:191]
  v_mfma_f32_32x32x16_bf16 v[160:175], v[28:31], v[60:63], v[160:175]
  v_mfma_f32_32x32x16_bf16 v[144:159], v[28:31], v[56:59], v[144:159]
  v_mfma_f32_32x32x16_bf16 v[128:143], v[28:31], v[52:55], v[128:143]
  ds_read_b64_tr_b16 v[28:29], v11 offset:1568
  ds_read_b64_tr_b16 v[30:31], v11 offset:1536
  ds_read_b128 v[64:67], v12 offset:512
  v_mfma_f32_32x32x16_bf16 v[176:191], v[32:35], v[60:63], v[176:191]
  v_mfma_f32_32x32x16_bf16 v[160:175], v[32:35], v[56:59], v[160:175]
  v_mfma_f32_32x32x16_bf16 v[144:159], v[32:35], v[52:55], v[144:159]
  v_mfma_f32_32x32x16_bf16 v[128:143], v[32:35], v[48:51], v[128:143]
  ds_read_b64_tr_b16 v[32:33], v11 offset:2080
  ds_read_b64_tr_b16 v[34:35], v11 offset:2048
  ds_read_b128 v[60:63], v12 offset:384
  v_mfma_f32_32x32x16_bf16 v[176:191], v[36:39], v[56:59], v[176:191]
  v_mfma_f32_32x32x16_bf16 v[160:175], v[36:39], v[52:55], v[160:175]
  v_mfma_f32_32x32x16_bf16 v[144:159], v[36:39], v[48:51], v[144:159]
  ds_read_b64_tr_b16 v[36:37], v11 offset:2592
  ds_read_b64_tr_b16 v[38:39], v11 offset:2560
  ds_read_b128 v[56:59], v12 offset:256
  v_mfma_f32_32x32x16_bf16 v[176:191], v[40:43], v[52:55], v[176:191]
  v_mfma_f32_32x32x16_bf16 v[160:175], v[40:43], v[48:51], v[160:175]
  ds_read_b64_tr_b16 v[40:41], v11 offset:3104
  ds_read_b64_tr_b16 v[42:43], v11 offset:3072
  ds_read_b128 v[52:55], v12 offset:128
  v_mfma_f32_32x32x16_bf16 v[176:191], v[44:47], v[48:51], v[176:191]
  ds_read_b64_tr_b16 v[44:45], v11 offset:3616
  ds_read_b64_tr_b16 v[46:47], v11 offset:3584
  ds_read_b128 v[48:51], v12 offset:0
  v_add_u32 v11, 128, v11
  v_subrev_u32 v12, 32, v12
  s_add_u32 s56, s56, 1
  s_cmp_lt_u32 s56, 4
  s_cbranch_scc1 L_s_conv
  s_mov_b32 s56, 3
  s_nop 7
  v_mov_b32_dpp v80, v111 quad_perm:[1,0,3,2] row_mask:0xf bank_mask:0xf
  v_add_f32_dpp v111, v110, v111 quad_perm:[1,0,3,2] row_mask:0xf bank_mask:0xf
  v_add_f32_dpp v110, v109, v110 quad_perm:[1,0,3,2] row_mask:0xf bank_mask:0xf
  v_add_f32_dpp v109, v108, v109 quad_perm:[1,0,3,2] row_mask:0xf bank_mask:0xf
  v_add_f32_dpp v108, v107, v108 quad_perm:[1,0,3,2] row_mask:0xf bank_mask:0xf
  v_add_f32_dpp v107, v106, v107 quad_perm:[1,0,3,2] row_mask:0xf bank_mask:0xf
  v_add_f32_dpp v106, v105, v106 quad_perm:[1,0,3,2] row_mask:0xf bank_mask:0xf
  v_add_f32_dpp v105, v104, v105 quad_perm:[1,0,3,2] row_mask:0xf bank_mask:0xf
  v_add_f32_dpp v104, v103, v104 quad_perm:[1,0,3,2] row_mask:0xf bank_mask:0xf
  v_add_f32_dpp v103, v102, v103 quad_perm:[1,0,3,2] row_mask:0xf bank_mask:0xf
  v_add_f32_dpp v102, v101, v102 quad_perm:[1,0,3,2] row_mask:0xf bank_mask:0xf
  v_add_f32_dpp v101, v100, v101 quad_perm:[1,0,3,2] row_mask:0xf bank_mask:0xf
  v_add_f32_dpp v100, v99, v100 quad_perm:[1,0,3,2] row_mask:0xf bank_mask:0xf
  v_add_f32_dpp v99, v98, v99 quad_perm:[1,0,3,2] row_mask:0xf bank_mask:0xf
  v_add_f32_dpp v98, v97, v98 quad_perm:[1,0,3,2] row_mask:0xf bank_mask:0xf
  v_add_f32_dpp v97, v96, v97 quad_perm:[1,0,3,2] row_mask:0xf bank_mask:0xf
  v_mov_b32_dpp v82, v80 quad_perm:[2,3,0,1] row_mask:0xf bank_mask:0xf
  v_mov_b32_dpp v81, v111 quad_perm:[2,3,0,1] row_mask:0xf bank_mask:0xf
  v_add_f32_dpp v80, v110, v80 quad_perm:[2,3,0,1] row_mask:0xf bank_mask:0xf
  v_add_f32_dpp v111, v109, v111 quad_perm:[2,3,0,1] row_mask:0xf bank_mask:0xf
  v_add_f32_dpp v110, v108, v110 quad_perm:[2,3,0,1] row_mask:0xf bank_mask:0xf
  v_add_f32_dpp v109, v107, v109 quad_perm:[2,3,0,1] row_mask:0xf bank_mask:0xf
  v_add_f32_dpp v108, v106, v108 quad_perm:[2,3,0,1] row_mask:0xf bank_mask:0xf
  v_add_f32_dpp v107, v105, v107 quad_perm:[2,3,0,1] row_mask:0xf bank_mask:0xf
  v_add_f32_dpp v106, v104, v106 quad_perm:[2,3,0,1] row_mask:0xf bank_mask:0xf
  v_add_f32_dpp v105, v103, v105 quad_perm:[2,3,0,1] row_mask:0xf bank_mask:0xf
  v_add_f32_dpp v104, v102, v104 quad_perm:[2,3,0,1] row_mask:0xf bank_mask:0xf
  v_add_f32_dpp v103, v101, v103 quad_perm:[2,3,0,1] row_mask:0xf bank_mask:0xf
  v_add_f32_dpp v102, v100, v102 quad_perm:[2,3,0,1] row_mask:0xf bank_mask:0xf
  v_add_f32_dpp v101, v99, v101 quad_perm:[2,3,0,1] row_mask:0xf bank_mask:0xf
  v_add_f32_dpp v100, v98, v100 quad_perm:[2,3,0,1] row_mask:0xf bank_mask:0xf
  v_add_f32_dpp v99, v97, v99 quad_perm:[2,3,0,1] row_mask:0xf bank_mask:0xf
  v_add_f32_dpp v98, v96, v98 quad_perm:[2,3,0,1] row_mask:0xf bank_mask:0xf
  v_cvt_pk_bf16_f32 v84, v96, v97
  v_cvt_pk_bf16_f32 v85, v98, v99
  v_cvt_pk_bf16_f32 v86, v100, v101
  v_cvt_pk_bf16_f32 v87, v102, v103
  v_cvt_pk_bf16_f32 v88, v104, v105
  v_cvt_pk_bf16_f32 v89, v106, v107
  v_cvt_pk_bf16_f32 v90, v108, v109
  v_cvt_pk_bf16_f32 v91, v110, v111
  s_mov_b64 exec, s[62:63]
  ds_write_b128 v13, v[84:87] offset:0
  ds_write_b128 v13, v[88:91] offset:16
  ds_write_b128 v14, v[80:83] offset:0
  s_mov_b64 exec, -1
  v_mov_b32_dpp v80, v127 quad_perm:[1,0,3,2] row_mask:0xf bank_mask:0xf
  v_add_f32_dpp v127, v126, v127 quad_perm:[1,0,3,2] row_mask:0xf bank_mask:0xf
  v_add_f32_dpp v126, v125, v126 quad_perm:[1,0,3,2] row_mask:0xf bank_mask:0xf
  v_add_f32_dpp v125, v124, v125 quad_perm:[1,0,3,2] row_mask:0xf bank_mask:0xf
  v_add_f32_dpp v124, v123, v124 quad_perm:[1,0,3,2] row_mask:0xf bank_mask:0xf
  v_add_f32_dpp v123, v122, v123 quad_perm:[1,0,3,2] row_mask:0xf bank_mask:0xf
  v_add_f32_dpp v122, v121, v122 quad_perm:[1,0,3,2] row_mask:0xf bank_mask:0xf
  v_add_f32_dpp v121, v120, v121 quad_perm:[1,0,3,2] row_mask:0xf bank_mask:0xf
  v_add_f32_dpp v120, v119, v120 quad_perm:[1,0,3,2] row_mask:0xf bank_mask:0xf
  v_add_f32_dpp v119, v118, v119 quad_perm:[1,0,3,2] row_mask:0xf bank_mask:0xf
  v_add_f32_dpp v118, v117, v118 quad_perm:[1,0,3,2] row_mask:0xf bank_mask:0xf
  v_add_f32_dpp v117, v116, v117 quad_perm:[1,0,3,2] row_mask:0xf bank_mask:0xf
  v_add_f32_dpp v116, v115, v116 quad_perm:[1,0,3,2] row_mask:0xf bank_mask:0xf
  v_add_f32_dpp v115, v114, v115 quad_perm:[1,0,3,2] row_mask:0xf bank_mask:0xf
  v_add_f32_dpp v114, v113, v114 quad_perm:[1,0,3,2] row_mask:0xf bank_mask:0xf
  v_add_f32_dpp v113, v112, v113 quad_perm:[1,0,3,2] row_mask:0xf bank_mask:0xf
  v_mov_b32_dpp v82, v80 quad_perm:[2,3,0,1] row_mask:0xf bank_mask:0xf
  v_mov_b32_dpp v81, v127 quad_perm:[2,3,0,1] row_mask:0xf bank_mask:0xf
  v_add_f32_dpp v80, v126, v80 quad_perm:[2,3,0,1] row_mask:0xf bank_mask:0xf
  v_add_f32_dpp v127, v125, v127 quad_perm:[2,3,0,1] row_mask:0xf bank_mask:0xf
  v_add_f32_dpp v126, v124, v126 quad_perm:[2,3,0,1] row_mask:0xf bank_mask:0xf
  v_add_f32_dpp v125, v123, v125 quad_perm:[2,3,0,1] row_mask:0xf bank_mask:0xf
  v_add_f32_dpp v124, v122, v124 quad_perm:[2,3,0,1] row_mask:0xf bank_mask:0xf
  v_add_f32_dpp v123, v121, v123 quad_perm:[2,3,0,1] row_mask:0xf bank_mask:0xf
  v_add_f32_dpp v122, v120, v122 quad_perm:[2,3,0,1] row_mask:0xf bank_mask:0xf
  v_add_f32_dpp v121, v119, v121 quad_perm:[2,3,0,1] row_mask:0xf bank_mask:0xf
  v_add_f32_dpp v120, v118, v120 quad_perm:[2,3,0,1] row_mask:0xf bank_mask:0xf
  v_add_f32_dpp v119, v117, v119 quad_perm:[2,3,0,1] row_mask:0xf bank_mask:0xf
  v_add_f32_dpp v118, v116, v118 quad_perm:[2,3,0,1] row_mask:0xf bank_mask:0xf
  v_add_f32_dpp v117, v115, v117 quad_perm:[2,3,0,1] row_mask:0xf bank_mask:0xf
  v_add_f32_dpp v116, v114, v116 quad_perm:[2,3,0,1] row_mask:0xf bank_mask:0xf
  v_add_f32_dpp v115, v113, v115 quad_perm:[2,3,0,1] row_mask:0xf bank_mask:0xf
  v_add_f32_dpp v114, v112, v114 quad_perm:[2,3,0,1] row_mask:0xf bank_mask:0xf
  v_cvt_pk_bf16_f32 v84, v112, v113
  v_cvt_pk_bf16_f32 v85, v114, v115
  v_cvt_pk_bf16_f32 v86, v116, v117
  v_cvt_pk_bf16_f32 v87, v118, v119
  v_cvt_pk_bf16_f32 v88, v120, v121
  v_cvt_pk_bf16_f32 v89, v122, v123
  v_cvt_pk_bf16_f32 v90, v124, v125
  v_cvt_pk_bf16_f32 v91, v126, v127
  s_mov_b64 exec, s[62:63]
  ds_write_b128 v13, v[84:87] offset:512
  ds_write_b128 v13, v[88:91] offset:528
  ds_write_b128 v14, v[80:83] offset:256
  s_mov_b64 exec, -1
  v_mov_b32_dpp v80, v143 quad_perm:[1,0,3,2] row_mask:0xf bank_mask:0xf
  v_add_f32_dpp v143, v142, v143 quad_perm:[1,0,3,2] row_mask:0xf bank_mask:0xf
  v_add_f32_dpp v142, v141, v142 quad_perm:[1,0,3,2] row_mask:0xf bank_mask:0xf
  v_add_f32_dpp v141, v140, v141 quad_perm:[1,0,3,2] row_mask:0xf bank_mask:0xf
  v_add_f32_dpp v140, v139, v140 quad_perm:[1,0,3,2] row_mask:0xf bank_mask:0xf
  v_add_f32_dpp v139, v138, v139 quad_perm:[1,0,3,2] row_mask:0xf bank_mask:0xf
  v_add_f32_dpp v138, v137, v138 quad_perm:[1,0,3,2] row_mask:0xf bank_mask:0xf
  v_add_f32_dpp v137, v136, v137 quad_perm:[1,0,3,2] row_mask:0xf bank_mask:0xf
  v_add_f32_dpp v136, v135, v136 quad_perm:[1,0,3,2] row_mask:0xf bank_mask:0xf
  v_add_f32_dpp v135, v134, v135 quad_perm:[1,0,3,2] row_mask:0xf bank_mask:0xf
  v_add_f32_dpp v134, v133, v134 quad_perm:[1,0,3,2] row_mask:0xf bank_mask:0xf
  v_add_f32_dpp v133, v132, v133 quad_perm:[1,0,3,2] row_mask:0xf bank_mask:0xf
  v_add_f32_dpp v132, v131, v132 quad_perm:[1,0,3,2] row_mask:0xf bank_mask:0xf
  v_add_f32_dpp v131, v130, v131 quad_perm:[1,0,3,2] row_mask:0xf bank_mask:0xf
  v_add_f32_dpp v130, v129, v130 quad_perm:[1,0,3,2] row_mask:0xf bank_mask:0xf
  v_add_f32_dpp v129, v128, v129 quad_perm:[1,0,3,2] row_mask:0xf bank_mask:0xf
  v_mov_b32_dpp v82, v80 quad_perm:[2,3,0,1] row_mask:0xf bank_mask:0xf
  v_mov_b32_dpp v81, v143 quad_perm:[2,3,0,1] row_mask:0xf bank_mask:0xf
  v_add_f32_dpp v80, v142, v80 quad_perm:[2,3,0,1] row_mask:0xf bank_mask:0xf
  v_add_f32_dpp v143, v141, v143 quad_perm:[2,3,0,1] row_mask:0xf bank_mask:0xf
  v_add_f32_dpp v142, v140, v142 quad_perm:[2,3,0,1] row_mask:0xf bank_mask:0xf
  v_add_f32_dpp v141, v139, v141 quad_perm:[2,3,0,1] row_mask:0xf bank_mask:0xf
  v_add_f32_dpp v140, v138, v140 quad_perm:[2,3,0,1] row_mask:0xf bank_mask:0xf
  v_add_f32_dpp v139, v137, v139 quad_perm:[2,3,0,1] row_mask:0xf bank_mask:0xf
  v_add_f32_dpp v138, v136, v138 quad_perm:[2,3,0,1] row_mask:0xf bank_mask:0xf
  v_add_f32_dpp v137, v135, v137 quad_perm:[2,3,0,1] row_mask:0xf bank_mask:0xf
  v_add_f32_dpp v136, v134, v136 quad_perm:[2,3,0,1] row_mask:0xf bank_mask:0xf
  v_add_f32_dpp v135, v133, v135 quad_perm:[2,3,0,1] row_mask:0xf bank_mask:0xf
  v_add_f32_dpp v134, v132, v134 quad_perm:[2,3,0,1] row_mask:0xf bank_mask:0xf
  v_add_f32_dpp v133, v131, v133 quad_perm:[2,3,0,1] row_mask:0xf bank_mask:0xf
  v_add_f32_dpp v132, v130, v132 quad_perm:[2,3,0,1] row_mask:0xf bank_mask:0xf
  v_add_f32_dpp v131, v129, v131 quad_perm:[2,3,0,1] row_mask:0xf bank_mask:0xf
  v_add_f32_dpp v130, v128, v130 quad_perm:[2,3,0,1] row_mask:0xf bank_mask:0xf
  v_cvt_pk_bf16_f32 v84, v128, v129
  v_cvt_pk_bf16_f32 v85, v130, v131
  v_cvt_pk_bf16_f32 v86, v132, v133
  v_cvt_pk_bf16_f32 v87, v134, v135
  v_cvt_pk_bf16_f32 v88, v136, v137
  v_cvt_pk_bf16_f32 v89, v138, v139
  v_cvt_pk_bf16_f32 v90, v140, v141
  v_cvt_pk_bf16_f32 v91, v142, v143
  s_mov_b64 exec, s[62:63]
  ds_write_b128 v13, v[84:87] offset:2048
  ds_write_b128 v13, v[88:91] offset:2064
  ds_write_b128 v14, v[80:83] offset:1024
  s_mov_b64 exec, -1
  v_mov_b32_dpp v80, v159 quad_perm:[1,0,3,2] row_mask:0xf bank_mask:0xf
  v_add_f32_dpp v159, v158, v159 quad_perm:[1,0,3,2] row_mask:0xf bank_mask:0xf
  v_add_f32_dpp v158, v157, v158 quad_perm:[1,0,3,2] row_mask:0xf bank_mask:0xf
  v_add_f32_dpp v157, v156, v157 quad_perm:[1,0,3,2] row_mask:0xf bank_mask:0xf
  v_add_f32_dpp v156, v155, v156 quad_perm:[1,0,3,2] row_mask:0xf bank_mask:0xf
  v_add_f32_dpp v155, v154, v155 quad_perm:[1,0,3,2] row_mask:0xf bank_mask:0xf
  v_add_f32_dpp v154, v153, v154 quad_perm:[1,0,3,2] row_mask:0xf bank_mask:0xf
  v_add_f32_dpp v153, v152, v153 quad_perm:[1,0,3,2] row_mask:0xf bank_mask:0xf
  v_add_f32_dpp v152, v151, v152 quad_perm:[1,0,3,2] row_mask:0xf bank_mask:0xf
  v_add_f32_dpp v151, v150, v151 quad_perm:[1,0,3,2] row_mask:0xf bank_mask:0xf
  v_add_f32_dpp v150, v149, v150 quad_perm:[1,0,3,2] row_mask:0xf bank_mask:0xf
  v_add_f32_dpp v149, v148, v149 quad_perm:[1,0,3,2] row_mask:0xf bank_mask:0xf
  v_add_f32_dpp v148, v147, v148 quad_perm:[1,0,3,2] row_mask:0xf bank_mask:0xf
  v_add_f32_dpp v147, v146, v147 quad_perm:[1,0,3,2] row_mask:0xf bank_mask:0xf
  v_add_f32_dpp v146, v145, v146 quad_perm:[1,0,3,2] row_mask:0xf bank_mask:0xf
  v_add_f32_dpp v145, v144, v145 quad_perm:[1,0,3,2] row_mask:0xf bank_mask:0xf
  v_mov_b32_dpp v82, v80 quad_perm:[2,3,0,1] row_mask:0xf bank_mask:0xf
  v_mov_b32_dpp v81, v159 quad_perm:[2,3,0,1] row_mask:0xf bank_mask:0xf
  v_add_f32_dpp v80, v158, v80 quad_perm:[2,3,0,1] row_mask:0xf bank_mask:0xf
  v_add_f32_dpp v159, v157, v159 quad_perm:[2,3,0,1] row_mask:0xf bank_mask:0xf
  v_add_f32_dpp v158, v156, v158 quad_perm:[2,3,0,1] row_mask:0xf bank_mask:0xf
  v_add_f32_dpp v157, v155, v157 quad_perm:[2,3,0,1] row_mask:0xf bank_mask:0xf
  v_add_f32_dpp v156, v154, v156 quad_perm:[2,3,0,1] row_mask:0xf bank_mask:0xf
  v_add_f32_dpp v155, v153, v155 quad_perm:[2,3,0,1] row_mask:0xf bank_mask:0xf
  v_add_f32_dpp v154, v152, v154 quad_perm:[2,3,0,1] row_mask:0xf bank_mask:0xf
  v_add_f32_dpp v153, v151, v153 quad_perm:[2,3,0,1] row_mask:0xf bank_mask:0xf
  v_add_f32_dpp v152, v150, v152 quad_perm:[2,3,0,1] row_mask:0xf bank_mask:0xf
  v_add_f32_dpp v151, v149, v151 quad_perm:[2,3,0,1] row_mask:0xf bank_mask:0xf
  v_add_f32_dpp v150, v148, v150 quad_perm:[2,3,0,1] row_mask:0xf bank_mask:0xf
  v_add_f32_dpp v149, v147, v149 quad_perm:[2,3,0,1] row_mask:0xf bank_mask:0xf
  v_add_f32_dpp v148, v146, v148 quad_perm:[2,3,0,1] row_mask:0xf bank_mask:0xf
  v_add_f32_dpp v147, v145, v147 quad_perm:[2,3,0,1] row_mask:0xf bank_mask:0xf
  v_add_f32_dpp v146, v144, v146 quad_perm:[2,3,0,1] row_mask:0xf bank_mask:0xf
  v_cvt_pk_bf16_f32 v84, v144, v145
  v_cvt_pk_bf16_f32 v85, v146, v147
  v_cvt_pk_bf16_f32 v86, v148, v149
  v_cvt_pk_bf16_f32 v87, v150, v151
  v_cvt_pk_bf16_f32 v88, v152, v153
  v_cvt_pk_bf16_f32 v89, v154, v155
  v_cvt_pk_bf16_f32 v90, v156, v157
  v_cvt_pk_bf16_f32 v91, v158, v159
  s_mov_b64 exec, s[62:63]
  ds_write_b128 v13, v[84:87] offset:2560
  ds_write_b128 v13, v[88:91] offset:2576
  ds_write_b128 v14, v[80:83] offset:1280
  s_mov_b64 exec, -1
L_s_red3:
  v_mov_b32_dpp v80, v175 quad_perm:[1,0,3,2] row_mask:0xf bank_mask:0xf
  v_add_f32_dpp v175, v174, v175 quad_perm:[1,0,3,2] row_mask:0xf bank_mask:0xf
  v_add_f32_dpp v174, v173, v174 quad_perm:[1,0,3,2] row_mask:0xf bank_mask:0xf
  v_add_f32_dpp v173, v172, v173 quad_perm:[1,0,3,2] row_mask:0xf bank_mask:0xf
  v_add_f32_dpp v172, v171, v172 quad_perm:[1,0,3,2] row_mask:0xf bank_mask:0xf
  v_add_f32_dpp v171, v170, v171 quad_perm:[1,0,3,2] row_mask:0xf bank_mask:0xf
  v_add_f32_dpp v170, v169, v170 quad_perm:[1,0,3,2] row_mask:0xf bank_mask:0xf
  v_add_f32_dpp v169, v168, v169 quad_perm:[1,0,3,2] row_mask:0xf bank_mask:0xf
  v_add_f32_dpp v168, v167, v168 quad_perm:[1,0,3,2] row_mask:0xf bank_mask:0xf
  v_add_f32_dpp v167, v166, v167 quad_perm:[1,0,3,2] row_mask:0xf bank_mask:0xf
  v_add_f32_dpp v166, v165, v166 quad_perm:[1,0,3,2] row_mask:0xf bank_mask:0xf
  v_add_f32_dpp v165, v164, v165 quad_perm:[1,0,3,2] row_mask:0xf bank_mask:0xf
  v_add_f32_dpp v164, v163, v164 quad_perm:[1,0,3,2] row_mask:0xf bank_mask:0xf
  v_add_f32_dpp v163, v162, v163 quad_perm:[1,0,3,2] row_mask:0xf bank_mask:0xf
  v_add_f32_dpp v162, v161, v162 quad_perm:[1,0,3,2] row_mask:0xf bank_mask:0xf
  v_add_f32_dpp v161, v160, v161 quad_perm:[1,0,3,2] row_mask:0xf bank_mask:0xf
  v_mov_b32_dpp v82, v80 quad_perm:[2,3,0,1] row_mask:0xf bank_mask:0xf
  v_mov_b32_dpp v81, v175 quad_perm:[2,3,0,1] row_mask:0xf bank_mask:0xf
  v_add_f32_dpp v80, v174, v80 quad_perm:[2,3,0,1] row_mask:0xf bank_mask:0xf
  v_add_f32_dpp v175, v173, v175 quad_perm:[2,3,0,1] row_mask:0xf bank_mask:0xf
  v_add_f32_dpp v174, v172, v174 quad_perm:[2,3,0,1] row_mask:0xf bank_mask:0xf
  v_add_f32_dpp v173, v171, v173 quad_perm:[2,3,0,1] row_mask:0xf bank_mask:0xf
  v_add_f32_dpp v172, v170, v172 quad_perm:[2,3,0,1] row_mask:0xf bank_mask:0xf
  v_add_f32_dpp v171, v169, v171 quad_perm:[2,3,0,1] row_mask:0xf bank_mask:0xf
  v_add_f32_dpp v170, v168, v170 quad_perm:[2,3,0,1] row_mask:0xf bank_mask:0xf
  v_add_f32_dpp v169, v167, v169 quad_perm:[2,3,0,1] row_mask:0xf bank_mask:0xf
  v_add_f32_dpp v168, v166, v168 quad_perm:[2,3,0,1] row_mask:0xf bank_mask:0xf
  v_add_f32_dpp v167, v165, v167 quad_perm:[2,3,0,1] row_mask:0xf bank_mask:0xf
  v_add_f32_dpp v166, v164, v166 quad_perm:[2,3,0,1] row_mask:0xf bank_mask:0xf
  v_add_f32_dpp v165, v163, v165 quad_perm:[2,3,0,1] row_mask:0xf bank_mask:0xf
  v_add_f32_dpp v164, v162, v164 quad_perm:[2,3,0,1] row_mask:0xf bank_mask:0xf
  v_add_f32_dpp v163, v161, v163 quad_perm:[2,3,0,1] row_mask:0xf bank_mask:0xf
  v_add_f32_dpp v162, v160, v162 quad_perm:[2,3,0,1] row_mask:0xf bank_mask:0xf
  v_cvt_pk_bf16_f32 v84, v160, v161
  v_cvt_pk_bf16_f32 v85, v162, v163
  v_cvt_pk_bf16_f32 v86, v164, v165
  v_cvt_pk_bf16_f32 v87, v166, v167
  v_cvt_pk_bf16_f32 v88, v168, v169
  v_cvt_pk_bf16_f32 v89, v170, v171
  v_cvt_pk_bf16_f32 v90, v172, v173
  v_cvt_pk_bf16_f32 v91, v174, v175
  s_mov_b64 exec, s[62:63]
  ds_write_b128 v13, v[84:87] offset:3072
  ds_write_b128 v13, v[88:91] offset:3088
  ds_write_b128 v14, v[80:83] offset:1536
  s_mov_b64 exec, -1
  v_mov_b32_dpp v80, v191 quad_perm:[1,0,3,2] row_mask:0xf bank_mask:0xf
  v_add_f32_dpp v191, v190, v191 quad_perm:[1,0,3,2] row_mask:0xf bank_mask:0xf
  v_add_f32_dpp v190, v189, v190 quad_perm:[1,0,3,2] row_mask:0xf bank_mask:0xf
  v_add_f32_dpp v189, v188, v189 quad_perm:[1,0,3,2] row_mask:0xf bank_mask:0xf
  v_add_f32_dpp v188, v187, v188 quad_perm:[1,0,3,2] row_mask:0xf bank_mask:0xf
  v_add_f32_dpp v187, v186, v187 quad_perm:[1,0,3,2] row_mask:0xf bank_mask:0xf
  v_add_f32_dpp v186, v185, v186 quad_perm:[1,0,3,2] row_mask:0xf bank_mask:0xf
  v_add_f32_dpp v185, v184, v185 quad_perm:[1,0,3,2] row_mask:0xf bank_mask:0xf
  v_add_f32_dpp v184, v183, v184 quad_perm:[1,0,3,2] row_mask:0xf bank_mask:0xf
  v_add_f32_dpp v183, v182, v183 quad_perm:[1,0,3,2] row_mask:0xf bank_mask:0xf
  v_add_f32_dpp v182, v181, v182 quad_perm:[1,0,3,2] row_mask:0xf bank_mask:0xf
  v_add_f32_dpp v181, v180, v181 quad_perm:[1,0,3,2] row_mask:0xf bank_mask:0xf
  v_add_f32_dpp v180, v179, v180 quad_perm:[1,0,3,2] row_mask:0xf bank_mask:0xf
  v_add_f32_dpp v179, v178, v179 quad_perm:[1,0,3,2] row_mask:0xf bank_mask:0xf
  v_add_f32_dpp v178, v177, v178 quad_perm:[1,0,3,2] row_mask:0xf bank_mask:0xf
  v_add_f32_dpp v177, v176, v177 quad_perm:[1,0,3,2] row_mask:0xf bank_mask:0xf
  v_mov_b32_dpp v82, v80 quad_perm:[2,3,0,1] row_mask:0xf bank_mask:0xf
  v_mov_b32_dpp v81, v191 quad_perm:[2,3,0,1] row_mask:0xf bank_mask:0xf
  v_add_f32_dpp v80, v190, v80 quad_perm:[2,3,0,1] row_mask:0xf bank_mask:0xf
  v_add_f32_dpp v191, v189, v191 quad_perm:[2,3,0,1] row_mask:0xf bank_mask:0xf
  v_add_f32_dpp v190, v188, v190 quad_perm:[2,3,0,1] row_mask:0xf bank_mask:0xf
  v_add_f32_dpp v189, v187, v189 quad_perm:[2,3,0,1] row_mask:0xf bank_mask:0xf
  v_add_f32_dpp v188, v186, v188 quad_perm:[2,3,0,1] row_mask:0xf bank_mask:0xf
  v_add_f32_dpp v187, v185, v187 quad_perm:[2,3,0,1] row_mask:0xf bank_mask:0xf
  v_add_f32_dpp v186, v184, v186 quad_perm:[2,3,0,1] row_mask:0xf bank_mask:0xf
  v_add_f32_dpp v185, v183, v185 quad_perm:[2,3,0,1] row_mask:0xf bank_mask:0xf
  v_add_f32_dpp v184, v182, v184 quad_perm:[2,3,0,1] row_mask:0xf bank_mask:0xf
  v_add_f32_dpp v183, v181, v183 quad_perm:[2,3,0,1] row_mask:0xf bank_mask:0xf
  v_add_f32_dpp v182, v180, v182 quad_perm:[2,3,0,1] row_mask:0xf bank_mask:0xf
  v_add_f32_dpp v181, v179, v181 quad_perm:[2,3,0,1] row_mask:0xf bank_mask:0xf
  v_add_f32_dpp v180, v178, v180 quad_perm:[2,3,0,1] row_mask:0xf bank_mask:0xf
  v_add_f32_dpp v179, v177, v179 quad_perm:[2,3,0,1] row_mask:0xf bank_mask:0xf
  v_add_f32_dpp v178, v176, v178 quad_perm:[2,3,0,1] row_mask:0xf bank_mask:0xf
  v_cvt_pk_bf16_f32 v84, v176, v177
  v_cvt_pk_bf16_f32 v85, v178, v179
  v_cvt_pk_bf16_f32 v86, v180, v181
  v_cvt_pk_bf16_f32 v87, v182, v183
  v_cvt_pk_bf16_f32 v88, v184, v185
  v_cvt_pk_bf16_f32 v89, v186, v187
  v_cvt_pk_bf16_f32 v90, v188, v189
  v_cvt_pk_bf16_f32 v91, v190, v191
  s_mov_b64 exec, s[62:63]
  ds_write_b128 v13, v[84:87] offset:3584
  ds_write_b128 v13, v[88:91] offset:3600
  ds_write_b128 v14, v[80:83] offset:1792
  s_mov_b64 exec, -1
  s_add_u32 s56, s56, 1
  s_cmp_ge_u32 s56, 3
  s_cbranch_scc1 L_s_fin
  v_add_u32 v13, 4096, v13
  v_add_u32 v14, 2080, v14
  s_branch L_s_w3ch
L_s_w3:
  v_mov_b32 v11, v3
  v_mov_b32 v12, v5
  v_subrev_u32 v13, 2048, v7
  v_subrev_u32 v14, 1024, v8
  s_mov_b32 s56, 0
  ds_read_b64_tr_b16 v[16:17], v11 offset:32
  ds_read_b64_tr_b16 v[18:19], v11 offset:0
  ds_read_b128 v[60:63], v12 offset:384
  ds_read_b64_tr_b16 v[20:21], v11 offset:544
  ds_read_b64_tr_b16 v[22:23], v11 offset:512
  ds_read_b128 v[56:59], v12 offset:256
  ds_read_b64_tr_b16 v[24:25], v11 offset:1056
  ds_read_b64_tr_b16 v[26:27], v11 offset:1024
  ds_read_b128 v[52:55], v12 offset:128
  ds_read_b64_tr_b16 v[28:29], v11 offset:1568
  ds_read_b64_tr_b16 v[30:31], v11 offset:1536
  ds_read_b128 v[48:51], v12 offset:0
L_s_w3ch:
  v_mov_b32 v160, 0
  v_mov_b32 v161, 0
  v_mov_b32 v162, 0
  v_mov_b32 v163, 0
  v_mov_b32 v164, 0
  v_mov_b32 v165, 0
  v_mov_b32 v166, 0
  v_mov_b32 v167, 0
  v_mov_b32 v168, 0
  v_mov_b32 v169, 0
  v_mov_b32 v170, 0
  v_mov_b32 v171, 0
  v_mov_b32 v172, 0
  v_mov_b32 v173, 0
  v_mov_b32 v174, 0
  v_mov_b32 v175, 0
  v_mov_b32 v176, 0
  v_mov_b32 v177, 0
  v_mov_b32 v178, 0
  v_mov_b32 v179, 0
  v_mov_b32 v180, 0
  v_mov_b32 v181, 0
  v_mov_b32 v182, 0
  v_mov_b32 v183, 0
  v_mov_b32 v184, 0
  v_mov_b32 v185, 0
  v_mov_b32 v186, 0
  v_mov_b32 v187, 0
  v_mov_b32 v188, 0
  v_mov_b32 v189, 0
  v_mov_b32 v190, 0
  v_mov_b32 v191, 0
  v_add_u32 v11, 128, v11
  v_subrev_u32 v12, 32, v12
  ds_read_b64_tr_b16 v[32:33], v11 offset:32
  ds_read_b64_tr_b16 v[34:35], v11 offset:0
  ds_read_b128 v[76:79], v12 offset:384
  ds_read_b64_tr_b16 v[36:37], v11 offset:544
  ds_read_b64_tr_b16 v[38:39], v11 offset:512
  ds_read_b128 v[72:75], v12 offset:256
  ds_read_b64_tr_b16 v[40:41], v11 offset:1056
  ds_read_b64_tr_b16 v[42:43], v11 offset:1024
  ds_read_b128 v[68:71], v12 offset:128
  ds_read_b64_tr_b16 v[44:45], v11 offset:1568
  ds_read_b64_tr_b16 v[46:47], v11 offset:1536
  ds_read_b128 v[64:67], v12 offset:0
  s_waitcnt lgkmcnt(12)
  v_mfma_f32_32x32x16_bf16 v[176:191], v[16:19], v[60:63], v[176:191]
  v_mfma_f32_32x32x16_bf16 v[160:175], v[16:19], v[56:59], v[160:175]
  v_mfma_f32_32x32x16_bf16 v[176:191], v[20:23], v[56:59], v[176:191]
  v_mfma_f32_32x32x16_bf16 v[160:175], v[20:23], v[52:55], v[160:175]
  v_mfma_f32_32x32x16_bf16 v[176:191], v[24:27], v[52:55], v[176:191]
  v_mfma_f32_32x32x16_bf16 v[160:175], v[24:27], v[48:51], v[160:175]
  v_mfma_f32_32x32x16_bf16 v[176:191], v[28:31], v[48:51], v[176:191]
  v_add_u32 v11, 128, v11
  v_subrev_u32 v12, 32, v12
  ds_read_b64_tr_b16 v[16:17], v11 offset:32
  ds_read_b64_tr_b16 v[18:19], v11 offset:0
  ds_read_b128 v[60:63], v12 offset:384
  ds_read_b64_tr_b16 v[20:21], v11 offset:544
  ds_read_b64_tr_b16 v[22:23], v11 offset:512
  ds_read_b128 v[56:59], v12 offset:256
  ds_read_b64_tr_b16 v[24:25], v11 offset:1056
  ds_read_b64_tr_b16 v[26:27], v11 offset:1024
  ds_read_b128 v[52:55], v12 offset:128
  ds_read_b64_tr_b16 v[28:29], v11 offset:1568
  ds_read_b64_tr_b16 v[30:31], v11 offset:1536
  ds_read_b128 v[48:51], v12 offset:0
  s_waitcnt lgkmcnt(12)
  v_mfma_f32_32x32x16_bf16 v[176:191], v[32:35], v[76:79], v[176:191]
  v_mfma_f32_32x32x16_bf16 v[160:175], v[32:35], v[72:75], v[160:175]
  v_mfma_f32_32x32x16_bf16 v[176:191], v[36:39], v[72:75], v[176:191]
  v_mfma_f32_32x32x16_bf16 v[160:175], v[36:39], v[68:71], v[160:175]
  v_mfma_f32_32x32x16_bf16 v[176:191], v[40:43], v[68:71], v[176:191]
  v_mfma_f32_32x32x16_bf16 v[160:175], v[40:43], v[64:67], v[160:175]
  v_mfma_f32_32x32x16_bf16 v[176:191], v[44:47], v[64:67], v[176:191]
  v_add_u32 v11, 128, v11
  v_subrev_u32 v12, 32, v12
  ds_read_b64_tr_b16 v[32:33], v11 offset:32
  ds_read_b64_tr_b16 v[34:35], v11 offset:0
  ds_read_b128 v[76:79], v12 offset:384
  ds_read_b64_tr_b16 v[36:37], v11 offset:544
  ds_read_b64_tr_b16 v[38:39], v11 offset:512
  ds_read_b128 v[72:75], v12 offset:256
  ds_read_b64_tr_b16 v[40:41], v11 offset:1056
  ds_read_b64_tr_b16 v[42:43], v11 offset:1024
  ds_read_b128 v[68:71], v12 offset:128
  ds_read_b64_tr_b16 v[44:45], v11 offset:1568
  ds_read_b64_tr_b16 v[46:47], v11 offset:1536
  ds_read_b128 v[64:67], v12 offset:0
  s_waitcnt lgkmcnt(12)
  v_mfma_f32_32x32x16_bf16 v[176:191], v[16:19], v[60:63], v[176:191]
  v_mfma_f32_32x32x16_bf16 v[160:175], v[16:19], v[56:59], v[160:175]
  v_mfma_f32_32x32x16_bf16 v[176:191], v[20:23], v[56:59], v[176:191]
  v_mfma_f32_32x32x16_bf16 v[160:175], v[20:23], v[52:55], v[160:175]
  v_mfma_f32_32x32x16_bf16 v[176:191], v[24:27], v[52:55], v[176:191]
  v_mfma_f32_32x32x16_bf16 v[160:175], v[24:27], v[48:51], v[160:175]
  v_mfma_f32_32x32x16_bf16 v[176:191], v[28:31], v[48:51], v[176:191]
  v_add_u32 v11, 3776, v11
  v_add_u32 v12, 5472, v12
  ds_read_b64_tr_b16 v[16:17], v11 offset:32
  ds_read_b64_tr_b16 v[18:19], v11 offset:0
  ds_read_b128 v[60:63], v12 offset:384
  ds_read_b64_tr_b16 v[20:21], v11 offset:544
  ds_read_b64_tr_b16 v[22:23], v11 offset:512
  ds_read_b128 v[56:59], v12 offset:256
  ds_read_b64_tr_b16 v[24:25], v11 offset:1056
  ds_read_b64_tr_b16 v[26:27], v11 offset:1024
  ds_read_b128 v[52:55], v12 offset:128
  ds_read_b64_tr_b16 v[28:29], v11 offset:1568
  ds_read_b64_tr_b16 v[30:31], v11 offset:1536
  ds_read_b128 v[48:51], v12 offset:0
  s_waitcnt lgkmcnt(12)
  v_mfma_f32_32x32x16_bf16 v[176:191], v[32:35], v[76:79], v[176:191]
  v_mfma_f32_32x32x16_bf16 v[160:175], v[32:35], v[72:75], v[160:175]
  v_mfma_f32_32x32x16_bf16 v[176:191], v[36:39], v[72:75], v[176:191]
  v_mfma_f32_32x32x16_bf16 v[160:175], v[36:39], v[68:71], v[160:175]
  v_mfma_f32_32x32x16_bf16 v[176:191], v[40:43], v[68:71], v[176:191]
  v_mfma_f32_32x32x16_bf16 v[160:175], v[40:43], v[64:67], v[160:175]
  v_mfma_f32_32x32x16_bf16 v[176:191], v[44:47], v[64:67], v[176:191]
  s_nop 7
  s_nop 3
  s_branch L_s_red3
L_s_fin:
  v_lshlrev_b32 v3, 4, v0
  v_lshlrev_b32 v4, 3, v0
  v_and_b32 v5, 1, v0
  v_cmp_eq_u32 vcc, 0, v5
  s_nop 1
  v_cndmask_b32 v4, 0, v4, vcc
  s_lshl_b32 s57, s25, 12
  s_mov_b32 s58, 0xffff0000
  s_waitcnt lgkmcnt(0)
  s_barrier
  ds_read_b128 v[16:19], v3 offset:4096
  ds_read_b128 v[20:23], v4 offset:16384
  ds_read_b128 v[24:27], v3 offset:8192
  ds_read_b128 v[28:31], v4 offset:18464
  ds_read_b128 v[32:35], v3 offset:12288
  ds_read_b128 v[36:39], v4 offset:20544
  s_waitcnt lgkmcnt(4)
  v_lshlrev_b32 v40, 16, v16
  v_and_b32 v41, s58, v16
  v_lshlrev_b32 v42, 16, v17
  v_and_b32 v43, s58, v17
  v_pk_add_f32 v[40:41], v[40:41], v[20:21]
  v_add_f32 v42, v42, v22
  v_cvt_pk_bf16_f32 v16, v40, v41
  v_cvt_pk_bf16_f32 v17, v42, v43
  buffer_store_dwordx4 v[16:19], v3, s[44:47], s57 offen sc1
  s_add_u32 s57, s57, 4096
  s_waitcnt lgkmcnt(2)
  v_lshlrev_b32 v40, 16, v24
  v_and_b32 v41, s58, v24
  v_lshlrev_b32 v42, 16, v25
  v_and_b32 v43, s58, v25
  v_pk_add_f32 v[40:41], v[40:41], v[28:29]
  v_add_f32 v42, v42, v30
  v_cvt_pk_bf16_f32 v24, v40, v41
  v_cvt_pk_bf16_f32 v25, v42, v43
  buffer_store_dwordx4 v[24:27], v3, s[44:47], s57 offen sc1
  s_add_u32 s57, s57, 4096
  s_cmp_eq_u32 s19, 26
  s_cselect_b32 s57, 0x40000000, s57
  s_waitcnt lgkmcnt(0)
  v_lshlrev_b32 v40, 16, v32
  v_and_b32 v41, s58, v32
  v_lshlrev_b32 v42, 16, v33
  v_and_b32 v43, s58, v33
  v_pk_add_f32 v[40:41], v[40:41], v[36:37]
  v_add_f32 v42, v42, v38
  v_cvt_pk_bf16_f32 v32, v40, v41
  v_cvt_pk_bf16_f32 v33, v42, v43
  buffer_store_dwordx4 v[32:35], v3, s[44:47], s57 offen sc1
  s_add_u32 s57, s57, 4096
  v_lshlrev_b32 v251, 11, v2
  s_lshl_b32 s58, s18, 6
  s_add_u32 s58, s58, s19
  s_lshl_b32 s58, s58, 2
  s_add_u32 s58, s58, 131200
  s_waitcnt vmcnt(0)
  s_barrier
  s_cmp_lg_u32 s12, 0
  s_cbranch_scc1 Lsig_36
  v_mov_b32 v250, s15
  s_mov_b64 exec, 0xffffffff
  buffer_store_dword v250, v251, s[8:11], s58 offen sc1
  s_mov_b64 exec, -1
Lsig_36:
  s_endpgm
.section .rodata,"a"
.p2align 6
.amdhsa_kernel recurrent_scan__ssm_conv_s4__mixer_channel_mlp__prompt_kernel
  .amdhsa_next_free_vgpr 256
  .amdhsa_next_free_sgpr 102
  .amdhsa_accum_offset 256
  .amdhsa_group_segment_fixed_size 0
  .amdhsa_kernarg_size 136
  .amdhsa_user_sgpr_count 2
  .amdhsa_user_sgpr_kernarg_segment_ptr 1
  .amdhsa_system_sgpr_workgroup_id_x 1
.end_amdhsa_kernel
```
